```python
import torch

def _softmax(x, axis=-1):
    return torch.softmax(x, dim=axis)
def _gelu(x):
    return torch.nn.functional.gelu(x, approximate="tanh")
def _silu(x):
    return torch.nn.functional.silu(x)
def _sigmoid(x):
    return torch.sigmoid(x)
def _layernorm(x, axis=-1, eps=1e-5):
    m = x.mean(dim=axis, keepdim=True)
    v = x.var(dim=axis, keepdim=True, unbiased=False)
    return (x - m) / torch.sqrt(v + eps)
def _scatter_add(tgt, idx, src, axis=0):
    return tgt.clone().index_add_(axis, idx, src)
def _segment_sum(src, seg, n):
    out = torch.zeros((n,) + src.shape[1:], dtype=src.dtype)
    return out.index_add_(0, seg, src)
def _pad(x, pw):
    flat = tuple(v for pair in reversed(pw) for v in pair)
    return torch.nn.functional.pad(x, flat)

kernel_name = 'sequential_preLN__softmax_full_mha__dense_activation_relu__prompt'

def setup_inputs():

    _w = (lambda a: (lambda t: t.to(torch.bfloat16) if t.is_floating_point() else t)(torch.as_tensor(a)))
    def _A_setup():
        B, S, D = 1, 2048, 640
        return {
            "x": _w((lambda *s: torch.randn(*s, dtype=torch.bfloat16) * 0.05)(B, S, D)),
            "wqkv": _w((lambda *s: torch.randn(*s, dtype=torch.bfloat16) * 0.05)(D, 3 * D)),
            "wo": _w((lambda *s: torch.randn(*s, dtype=torch.bfloat16) * 0.05)(D, D)),
        }
    _A_in = _A_setup()

    def _B_setup():
        B, S, D, Dff = 1, 2048, 640, 1728
        return {
            "x": _w((lambda *s: torch.randn(*s, dtype=torch.bfloat16) * 0.05)(B, S, D)),
            "w1": _w((lambda *s: torch.randn(*s, dtype=torch.bfloat16) * 0.05)(D, Dff)),
            "w2": _w((lambda *s: torch.randn(*s, dtype=torch.bfloat16) * 0.05)(Dff, D)),
        }
    _B_in = _B_setup()

    return {
        "A_x": _A_in["x"],
        "A_wqkv": _A_in["wqkv"],
        "A_wo": _A_in["wo"],
        "B_x": _B_in["x"],
        "B_w1": _B_in["w1"],
        "B_w2": _B_in["w2"],
    }

def reference(A_x, A_wqkv, A_wo, B_x, B_w1, B_w2):
    def _A_ref(x, wqkv, wo):
        B, S, D = x.shape
        H = 32; Dh = D // H
        qkv = (lambda x, *d: x.permute(*d))((x @ wqkv).reshape(B, S, 3, H, Dh), 2, 0, 3, 1, 4)
        q, k, v = qkv[0], qkv[1], qkv[2]
        scale = Dh ** -0.5
        scores = torch.einsum("bhqd,bhkd->bhqk", q, k) * scale
        p = _softmax(scores, axis=-1)
        o = torch.einsum("bhqk,bhkd->bhqd", p, v)
        return (lambda x, *d: x.permute(*d))(o, 0, 2, 1, 3).reshape(B, S, D) @ wo

    def _B_ref(x, w1, w2):
        h = torch.einsum("bsd,df->bsf", x, w1)
        zero = torch.zeros_like(h)
        h = torch.maximum(h, zero)
        return torch.einsum("bsf,fd->bsd", h, w2)

    x = A_x
    h = x + _A_ref(_layernorm(x, axis=-1), A_wqkv, A_wo)
    h2 = h + _B_ref(_layernorm(h, axis=-1), B_w1, B_w2)
    return h2
```

```asm
; @launch grid=(256,1,1) block=(512,1,1) lds=163840
.amdgcn_target "amdgcn-amd-amdhsa--gfx950"
.text
.globl sequential_preLN__softmax_full_mha__dense_activation_relu__prompt_kernel
.p2align 8
.type sequential_preLN__softmax_full_mha__dense_activation_relu__prompt_kernel,@function
sequential_preLN__softmax_full_mha__dense_activation_relu__prompt_kernel:
  s_cmp_ge_u32 s2, 256
  s_cbranch_scc1 L_end
  s_load_dwordx16 s[64:79], s[0:1], 0
  s_load_dwordx2 s[80:81], s[0:1], 64
  v_lshrrev_b32 v2, 6, v0
  v_and_b32 v1, 63, v0
  s_and_b32 s33, s2, 7
  v_readfirstlane_b32 s32, v2
  s_lshr_b32 s34, s2, 3
  s_getpc_b64 s[82:83]
L_pc0:
  s_mov_b32 s61, L_code_end-L_pc0
  s_lshl_b32 s60, s32, 13
  v_lshlrev_b32 v3, 7, v1
  v_add_u32 v3, s60, v3
  v_cmp_gt_u32 vcc, s61, v3
  s_and_saveexec_b64 s[62:63], vcc
  s_cbranch_execz cpf_1
  global_load_dword v255, v3, s[82:83]
cpf_1:
  s_mov_b64 exec, s[62:63]
  s_waitcnt lgkmcnt(0)
  s_mov_b32 s4, s80
  s_and_b32 s5, s81, 0xffff
  s_mov_b32 s6, 26025984
  s_mov_b32 s7, 0x20000
  s_mov_b32 s8, s64
  s_and_b32 s9, s65, 0xffff
  s_mov_b32 s10, 2621440
  s_mov_b32 s11, 0x20000
  s_mov_b32 s12, s66
  s_and_b32 s13, s67, 0xffff
  s_mov_b32 s14, 2457600
  s_mov_b32 s15, 0x20000
  s_mov_b32 s16, s68
  s_and_b32 s17, s69, 0xffff
  s_mov_b32 s18, 819200
  s_mov_b32 s19, 0x20000
  s_mov_b32 s20, s72
  s_and_b32 s21, s73, 0xffff
  s_mov_b32 s22, 2211840
  s_mov_b32 s23, 0x20000
  s_mov_b32 s24, s74
  s_and_b32 s25, s75, 0xffff
  s_mov_b32 s26, 2211840
  s_mov_b32 s27, 0x20000
  s_mov_b32 s28, s76
  s_and_b32 s29, s77, 0xffff
  s_mov_b32 s30, 2621440
  s_mov_b32 s31, 0x20000
  s_load_dword s35, s[80:81], 0
  s_getreg_b32 s72, hwreg(HW_REG_XCC_ID, 0, 4)
  s_lshr_b32 s45, s33, 2
  s_lshl_b32 s45, s45, 3
  s_lshr_b32 s36, s34, 2
  s_add_u32 s36, s36, s45
  s_and_b32 s37, s33, 3
  s_lshl_b32 s37, s37, 2
  s_and_b32 s45, s34, 3
  s_add_u32 s37, s37, s45
  s_lshr_b32 s38, s32, 2
  s_and_b32 s39, s32, 3
  s_lshl_b32 s45, s2, 3
  s_add_u32 s45, s45, s32
  s_mul_i32 s46, s45, 1280
  v_lshlrev_b32 v2, 4, v1
  v_mov_b32 v180, 0
  v_mov_b32 v181, 0
  v_mov_b32 v182, 0
  v_mov_b32 v183, 0
  buffer_load_dwordx4 v[176:179], v2, s[8:11], s46 offen
  s_mov_b64 exec, 0xffff
  buffer_load_dwordx4 v[180:183], v2, s[8:11], s46 offen offset:1024
  s_mov_b64 exec, -1
  s_lshl_b32 s74, s45, 4
  s_add_u32 s74, s74, 8085504
  v_lshrrev_b32 v2, 3, v1
  s_lshl_b32 s45, s32, 4
  v_add_u32 v2, s45, v2
  v_mul_u32_u24 v2, 1280, v2
  v_and_b32 v3, 7, v1
  v_lshrrev_b32 v4, 4, v1
  v_xor_b32 v5, v3, v4
  v_lshl_add_u32 v84, v5, 4, v2
  v_xor_b32 v5, 4, v5
  v_lshl_add_u32 v85, v5, 4, v2
  v_add_u32 v85, 9216, v85
  v_and_b32 v3, 15, v1
  v_lshlrev_b32 v5, 2, v4
  v_xor_b32 v3, v3, v5
  v_mul_u32_u24 v6, 3840, v4
  v_lshl_add_u32 v86, v3, 4, v6
  v_add_u32 v87, 14336, v86
  s_mul_i32 s41, s37, 163840
  s_mul_i32 s42, s32, 30720
  s_lshl_b32 s45, s36, 8
  s_add_u32 s42, s42, s45
  s_lshl_b32 s43, s32, 11
  s_cmp_eq_u32 s36, 15
  s_cbranch_scc1 P1_idle_2
  s_add_u32 m0, s43, 0
  s_nop 0
  buffer_load_dwordx4 v84, s[8:11], s41 offen lds
  buffer_load_dwordx4 v85, s[8:11], s41 offen offset:1024 lds
  s_add_u32 m0, m0, 16384
  s_add_u32 s41, s41, 128
  buffer_load_dwordx4 v86, s[12:15], s42 offen lds
  buffer_load_dwordx4 v87, s[12:15], s42 offen offset:1024 lds
  s_add_u32 s42, s42, 245760
  v_and_b32 v2, 31, v1
  v_lshrrev_b32 v3, 5, v1
  s_lshl_b32 s45, s39, 5
  v_add_u32 v4, s45, v2
  v_lshlrev_b32 v4, 7, v4
  v_bfe_u32 v5, v2, 1, 3
  s_xor_b32 s45, s39, 0
  s_lshl_b32 s45, s45, 1
  v_add_u32 v6, s45, v3
  v_xor_b32 v6, v6, v5
  v_lshl_add_u32 v72, v6, 4, v4
  s_xor_b32 s45, s39, 1
  s_lshl_b32 s45, s45, 1
  v_add_u32 v6, s45, v3
  v_xor_b32 v6, v6, v5
  v_lshl_add_u32 v73, v6, 4, v4
  s_xor_b32 s45, s39, 2
  s_lshl_b32 s45, s45, 1
  v_add_u32 v6, s45, v3
  v_xor_b32 v6, v6, v5
  v_lshl_add_u32 v74, v6, 4, v4
  s_xor_b32 s45, s39, 3
  s_lshl_b32 s45, s45, 1
  v_add_u32 v6, s45, v3
  v_xor_b32 v6, v6, v5
  v_lshl_add_u32 v75, v6, 4, v4
  s_add_u32 m0, s43, 32768
  s_nop 0
  buffer_load_dwordx4 v84, s[8:11], s41 offen lds
  buffer_load_dwordx4 v85, s[8:11], s41 offen offset:1024 lds
  s_add_u32 m0, m0, 16384
  s_add_u32 s41, s41, 128
  buffer_load_dwordx4 v86, s[12:15], s42 offen lds
  buffer_load_dwordx4 v87, s[12:15], s42 offen offset:1024 lds
  s_add_u32 s42, s42, 245760
  v_lshrrev_b32 v2, 4, v1
  v_and_b32 v3, 15, v1
  v_lshrrev_b32 v4, 1, v2
  v_and_b32 v5, 1, v2
  v_lshrrev_b32 v6, 2, v3
  v_lshl_add_u32 v4, v4, 3, v6
  v_lshlrev_b32 v4, 8, v4
  v_bfe_u32 v7, v3, 1, 1
  v_lshl_add_u32 v5, v5, 1, v7
  v_lshl_add_u32 v4, v5, 4, v4
  v_and_b32 v7, 1, v3
  v_lshl_add_u32 v4, v7, 3, v4
  v_add_u32 v4, 16384, v4
  s_lshl_b32 s45, s38, 1
  s_add_u32 s45, s45, 0
  v_xor_b32 v5, s45, v6
  v_lshl_add_u32 v5, v5, 6, v4
  s_xor_b32 s45, s39, 0
  s_lshl_b32 s45, s45, 12
  v_add_u32 v76, s45, v5
  s_xor_b32 s45, s39, 1
  s_lshl_b32 s45, s45, 12
  v_add_u32 v78, s45, v5
  s_xor_b32 s45, s39, 2
  s_lshl_b32 s45, s45, 12
  v_add_u32 v80, s45, v5
  s_xor_b32 s45, s39, 3
  s_lshl_b32 s45, s45, 12
  v_add_u32 v82, s45, v5
  s_lshl_b32 s45, s38, 1
  s_add_u32 s45, s45, 1
  v_xor_b32 v5, s45, v6
  v_lshl_add_u32 v5, v5, 6, v4
  s_xor_b32 s45, s39, 0
  s_lshl_b32 s45, s45, 12
  v_add_u32 v77, s45, v5
  s_xor_b32 s45, s39, 1
  s_lshl_b32 s45, s45, 12
  v_add_u32 v79, s45, v5
  s_xor_b32 s45, s39, 2
  s_lshl_b32 s45, s45, 12
  v_add_u32 v81, s45, v5
  s_xor_b32 s45, s39, 3
  s_lshl_b32 s45, s45, 12
  v_add_u32 v83, s45, v5
  s_add_u32 m0, s43, 65536
  s_nop 0
  buffer_load_dwordx4 v84, s[8:11], s41 offen lds
  buffer_load_dwordx4 v85, s[8:11], s41 offen offset:1024 lds
  s_add_u32 m0, m0, 16384
  s_add_u32 s41, s41, 128
  buffer_load_dwordx4 v86, s[12:15], s42 offen lds
  buffer_load_dwordx4 v87, s[12:15], s42 offen offset:1024 lds
  s_add_u32 s42, s42, 245760
  s_lshl_b32 s75, s37, 7
  s_lshl_b32 s46, s39, 5
  s_add_u32 s75, s75, s46
  s_lshl_b32 s75, s75, 4
  s_add_u32 s75, s75, 8085504
  v_and_b32 v56, 31, v1
  v_lshlrev_b32 v56, 4, v56
  v_mov_b32 v16, 0
  v_mov_b32 v17, 0
  v_mov_b32 v18, 0
  v_mov_b32 v19, 0
  v_mov_b32 v20, 0
  v_mov_b32 v21, 0
  v_mov_b32 v22, 0
  v_mov_b32 v23, 0
  v_mov_b32 v24, 0
  v_mov_b32 v25, 0
  v_mov_b32 v26, 0
  v_mov_b32 v27, 0
  v_mov_b32 v28, 0
  v_mov_b32 v29, 0
  v_mov_b32 v30, 0
  v_mov_b32 v31, 0
  v_mov_b32 v32, 0
  v_mov_b32 v33, 0
  v_mov_b32 v34, 0
  v_mov_b32 v35, 0
  v_mov_b32 v36, 0
  v_mov_b32 v37, 0
  v_mov_b32 v38, 0
  v_mov_b32 v39, 0
  v_mov_b32 v40, 0
  v_mov_b32 v41, 0
  v_mov_b32 v42, 0
  v_mov_b32 v43, 0
  v_mov_b32 v44, 0
  v_mov_b32 v45, 0
  v_mov_b32 v46, 0
  v_mov_b32 v47, 0
  v_mov_b32 v100, 0
  v_mov_b32 v101, 0
  v_mov_b32 v102, 0
  v_mov_b32 v103, 0
  v_mov_b32 v104, 0
  v_mov_b32 v105, 0
  v_mov_b32 v106, 0
  v_mov_b32 v107, 0
  v_and_b32 v2, 15, v1
  v_bfe_u32 v3, v1, 4, 1
  v_cmp_eq_u32 vcc, v2, v3
  v_mov_b32 v4, 0x3f803f80
  v_mov_b32 v5, 0
  v_cndmask_b32 v108, v5, v4, vcc
  v_mov_b32 v109, v108
  v_mov_b32 v110, v108
  v_mov_b32 v111, v108
  s_waitcnt lgkmcnt(0)
  s_mul_i32 s35, s35, 0x9e3779b1
  s_add_u32 s35, s35, 0x7f4a7c15
  s_waitcnt vmcnt(12)
  v_mov_b32 v92, 0
  v_mov_b32 v93, 0
  v_lshlrev_b32 v94, 16, v176
  v_and_b32 v95, 0xffff0000, v176
  v_add_f32 v92, v92, v94
  v_fmac_f32 v93, v94, v94
  v_add_f32 v92, v92, v95
  v_fmac_f32 v93, v95, v95
  v_lshlrev_b32 v94, 16, v177
  v_and_b32 v95, 0xffff0000, v177
  v_add_f32 v92, v92, v94
  v_fmac_f32 v93, v94, v94
  v_add_f32 v92, v92, v95
  v_fmac_f32 v93, v95, v95
  v_lshlrev_b32 v94, 16, v178
  v_and_b32 v95, 0xffff0000, v178
  v_add_f32 v92, v92, v94
  v_fmac_f32 v93, v94, v94
  v_add_f32 v92, v92, v95
  v_fmac_f32 v93, v95, v95
  v_lshlrev_b32 v94, 16, v179
  v_and_b32 v95, 0xffff0000, v179
  v_add_f32 v92, v92, v94
  v_fmac_f32 v93, v94, v94
  v_add_f32 v92, v92, v95
  v_fmac_f32 v93, v95, v95
  v_lshlrev_b32 v94, 16, v180
  v_and_b32 v95, 0xffff0000, v180
  v_add_f32 v92, v92, v94
  v_fmac_f32 v93, v94, v94
  v_add_f32 v92, v92, v95
  v_fmac_f32 v93, v95, v95
  v_lshlrev_b32 v94, 16, v181
  v_and_b32 v95, 0xffff0000, v181
  v_add_f32 v92, v92, v94
  v_fmac_f32 v93, v94, v94
  v_add_f32 v92, v92, v95
  v_fmac_f32 v93, v95, v95
  v_lshlrev_b32 v94, 16, v182
  v_and_b32 v95, 0xffff0000, v182
  v_add_f32 v92, v92, v94
  v_fmac_f32 v93, v94, v94
  v_add_f32 v92, v92, v95
  v_fmac_f32 v93, v95, v95
  v_lshlrev_b32 v94, 16, v183
  v_and_b32 v95, 0xffff0000, v183
  v_add_f32 v92, v92, v94
  v_fmac_f32 v93, v94, v94
  v_add_f32 v92, v92, v95
  v_fmac_f32 v93, v95, v95
  s_nop 0
  v_add_f32_dpp v92, v92, v92 row_shr:1 row_mask:0xf bank_mask:0xf bound_ctrl:0
  s_nop 1
  v_add_f32_dpp v92, v92, v92 row_shr:2 row_mask:0xf bank_mask:0xf bound_ctrl:0
  s_nop 1
  v_add_f32_dpp v92, v92, v92 row_shr:4 row_mask:0xf bank_mask:0xf bound_ctrl:0
  s_nop 1
  v_add_f32_dpp v92, v92, v92 row_shr:8 row_mask:0xf bank_mask:0xf bound_ctrl:0
  s_nop 1
  v_add_f32_dpp v92, v92, v92 row_bcast:15 row_mask:0xa bank_mask:0xf
  s_nop 1
  v_add_f32_dpp v92, v92, v92 row_bcast:31 row_mask:0xc bank_mask:0xf
  v_add_f32_dpp v93, v93, v93 row_shr:1 row_mask:0xf bank_mask:0xf bound_ctrl:0
  s_nop 1
  v_add_f32_dpp v93, v93, v93 row_shr:2 row_mask:0xf bank_mask:0xf bound_ctrl:0
  s_nop 1
  v_add_f32_dpp v93, v93, v93 row_shr:4 row_mask:0xf bank_mask:0xf bound_ctrl:0
  s_nop 1
  v_add_f32_dpp v93, v93, v93 row_shr:8 row_mask:0xf bank_mask:0xf bound_ctrl:0
  s_nop 1
  v_add_f32_dpp v93, v93, v93 row_bcast:15 row_mask:0xa bank_mask:0xf
  s_nop 1
  v_add_f32_dpp v93, v93, v93 row_bcast:31 row_mask:0xc bank_mask:0xf
  v_mul_f32 v92, 0x3acccccd, v92
  v_mul_f32 v93, 0x3acccccd, v93
  v_fma_f32 v93, -v92, v92, v93
  v_max_f32 v93, 0, v93
  v_add_f32 v93, 0x3727c5ac, v93
  v_rsq_f32 v94, v93
  v_mov_b32 v93, s35
  v_mov_b32 v95, s35
  v_mov_b32 v2, 0
  s_mov_b32 exec_lo, 0
  s_mov_b32 exec_hi, 0x80000000
  buffer_store_dwordx4 v[92:95], v2, s[4:7], s74 offen sc1
  s_mov_b64 exec, -1
  s_waitcnt vmcnt(9)
  s_barrier
  ds_read_b128 v[128:131], v72 offset:0
  ds_read_b64_tr_b16 v[144:145], v76 offset:0
  ds_read_b64_tr_b16 v[146:147], v76 offset:1024
  ds_read_b64_tr_b16 v[148:149], v77 offset:0
  ds_read_b64_tr_b16 v[150:151], v77 offset:1024
  ds_read_b128 v[132:135], v73 offset:0
  ds_read_b64_tr_b16 v[152:153], v78 offset:0
  ds_read_b64_tr_b16 v[154:155], v78 offset:1024
  ds_read_b64_tr_b16 v[156:157], v79 offset:0
  ds_read_b64_tr_b16 v[158:159], v79 offset:1024
  s_mov_b32 s44, 0
  s_mov_b32 s40, 0
  s_add_u32 s49, s38, 1
  s_cmp_ge_u32 s36, 10
  s_cbranch_scc1 P1_vtype_4
P1_loop_5:
  s_waitcnt lgkmcnt(5)
  v_mfma_f32_32x32x16_bf16 v[16:31], v[144:147], v[128:131], v[16:31]
  v_mfma_f32_32x32x16_bf16 v[32:47], v[148:151], v[128:131], v[32:47]
  ds_read_b128 v[136:139], v74 offset:0
  ds_read_b64_tr_b16 v[160:161], v80 offset:0
  ds_read_b64_tr_b16 v[162:163], v80 offset:1024
  ds_read_b64_tr_b16 v[164:165], v81 offset:0
  ds_read_b64_tr_b16 v[166:167], v81 offset:1024
  v_mfma_f32_16x16x32_bf16 v[100:103], v[108:111], v[144:147], v[100:103]
  v_mfma_f32_16x16x32_bf16 v[104:107], v[108:111], v[148:151], v[104:107]
  s_cmp_eq_u32 s40, 1
  s_cbranch_scc0 P1_nd_6
  s_add_u32 m0, s43, s48
  s_nop 0
  buffer_load_dwordx4 v84, s[8:11], s41 offen lds
  buffer_load_dwordx4 v85, s[8:11], s41 offen offset:1024 lds
  s_add_u32 s41, s41, 128
P1_nd_6:
  s_waitcnt lgkmcnt(5)
  v_mfma_f32_32x32x16_bf16 v[16:31], v[152:155], v[132:135], v[16:31]
  v_mfma_f32_32x32x16_bf16 v[32:47], v[156:159], v[132:135], v[32:47]
  ds_read_b128 v[140:143], v75 offset:0
  ds_read_b64_tr_b16 v[168:169], v82 offset:0
  ds_read_b64_tr_b16 v[170:171], v82 offset:1024
  ds_read_b64_tr_b16 v[172:173], v83 offset:0
  ds_read_b64_tr_b16 v[174:175], v83 offset:1024
  s_cmp_eq_u32 s40, 1
  s_cbranch_scc0 P1_nd_7
  s_add_u32 m0, m0, 16384
  s_nop 0
  buffer_load_dwordx4 v86, s[12:15], s42 offen lds
  buffer_load_dwordx4 v87, s[12:15], s42 offen offset:1024 lds
  s_add_u32 s42, s42, 245760
P1_nd_7:
  s_waitcnt lgkmcnt(5)
  v_mfma_f32_32x32x16_bf16 v[16:31], v[160:163], v[136:139], v[16:31]
  s_waitcnt vmcnt(4)
  s_cmp_lt_u32 s44, 8
  s_cbranch_scc1 P1_z_8
  s_waitcnt vmcnt(0)
P1_z_8:
  s_barrier
  v_mfma_f32_32x32x16_bf16 v[32:47], v[164:167], v[136:139], v[32:47]
  s_cmp_lt_u32 s44, 7
  s_cselect_b32 s40, s49, 0
  s_add_u32 s48, s44, 3
  s_and_b32 s48, s48, 3
  s_lshl_b32 s48, s48, 15
  ds_read_b128 v[128:131], v72 offset:32768
  ds_read_b64_tr_b16 v[144:145], v76 offset:32768
  ds_read_b64_tr_b16 v[146:147], v76 offset:33792
  ds_read_b64_tr_b16 v[148:149], v77 offset:32768
  ds_read_b64_tr_b16 v[150:151], v77 offset:33792
  s_cmp_eq_u32 s40, 2
  s_cbranch_scc0 P1_nd_9
  s_add_u32 m0, s43, s48
  s_nop 0
  buffer_load_dwordx4 v84, s[8:11], s41 offen lds
  buffer_load_dwordx4 v85, s[8:11], s41 offen offset:1024 lds
  s_add_u32 s41, s41, 128
P1_nd_9:
  s_waitcnt lgkmcnt(5)
  v_mfma_f32_32x32x16_bf16 v[16:31], v[168:171], v[140:143], v[16:31]
  v_mfma_f32_32x32x16_bf16 v[32:47], v[172:175], v[140:143], v[32:47]
  s_cmp_eq_u32 s44, 8
  s_cbranch_scc0 P1_gl_10
  buffer_load_dwordx4 v[92:95], v56, s[4:7], s75 offen sc1
P1_gl_10:
  ds_read_b128 v[132:135], v73 offset:32768
  ds_read_b64_tr_b16 v[152:153], v78 offset:32768
  ds_read_b64_tr_b16 v[154:155], v78 offset:33792
  ds_read_b64_tr_b16 v[156:157], v79 offset:32768
  ds_read_b64_tr_b16 v[158:159], v79 offset:33792
  s_cmp_eq_u32 s40, 2
  s_cbranch_scc0 P1_nd_11
  s_add_u32 m0, m0, 16384
  s_nop 0
  buffer_load_dwordx4 v86, s[12:15], s42 offen lds
  buffer_load_dwordx4 v87, s[12:15], s42 offen offset:1024 lds
  s_add_u32 s42, s42, 245760
P1_nd_11:
  s_waitcnt lgkmcnt(5)
  v_mfma_f32_32x32x16_bf16 v[16:31], v[144:147], v[128:131], v[16:31]
  v_mfma_f32_32x32x16_bf16 v[32:47], v[148:151], v[128:131], v[32:47]
  ds_read_b128 v[136:139], v74 offset:32768
  ds_read_b64_tr_b16 v[160:161], v80 offset:32768
  ds_read_b64_tr_b16 v[162:163], v80 offset:33792
  ds_read_b64_tr_b16 v[164:165], v81 offset:32768
  ds_read_b64_tr_b16 v[166:167], v81 offset:33792
  v_mfma_f32_16x16x32_bf16 v[100:103], v[108:111], v[144:147], v[100:103]
  v_mfma_f32_16x16x32_bf16 v[104:107], v[108:111], v[148:151], v[104:107]
  s_cmp_eq_u32 s40, 1
  s_cbranch_scc0 P1_nd_12
  s_add_u32 m0, s43, s48
  s_nop 0
  buffer_load_dwordx4 v84, s[8:11], s41 offen lds
  buffer_load_dwordx4 v85, s[8:11], s41 offen offset:1024 lds
  s_add_u32 s41, s41, 128
P1_nd_12:
  s_waitcnt lgkmcnt(5)
  v_mfma_f32_32x32x16_bf16 v[16:31], v[152:155], v[132:135], v[16:31]
  v_mfma_f32_32x32x16_bf16 v[32:47], v[156:159], v[132:135], v[32:47]
  ds_read_b128 v[140:143], v75 offset:32768
  ds_read_b64_tr_b16 v[168:169], v82 offset:32768
  ds_read_b64_tr_b16 v[170:171], v82 offset:33792
  ds_read_b64_tr_b16 v[172:173], v83 offset:32768
  ds_read_b64_tr_b16 v[174:175], v83 offset:33792
  v_xor_b32 v74, 0x10000, v74
  v_xor_b32 v80, 0x10000, v80
  v_xor_b32 v81, 0x10000, v81
  v_xor_b32 v75, 0x10000, v75
  v_xor_b32 v82, 0x10000, v82
  v_xor_b32 v83, 0x10000, v83
  s_cmp_eq_u32 s40, 1
  s_cbranch_scc0 P1_nd_13
  s_add_u32 m0, m0, 16384
  s_nop 0
  buffer_load_dwordx4 v86, s[12:15], s42 offen lds
  buffer_load_dwordx4 v87, s[12:15], s42 offen offset:1024 lds
  s_add_u32 s42, s42, 245760
P1_nd_13:
  s_waitcnt lgkmcnt(5)
  v_mfma_f32_32x32x16_bf16 v[16:31], v[160:163], v[136:139], v[16:31]
  s_waitcnt vmcnt(4)
  s_cmp_lt_u32 s44, 7
  s_cbranch_scc1 P1_z_14
  s_waitcnt vmcnt(0)
P1_z_14:
  s_barrier
  v_mfma_f32_32x32x16_bf16 v[32:47], v[164:167], v[136:139], v[32:47]
  s_cmp_lt_u32 s44, 6
  s_cselect_b32 s40, s49, 0
  s_add_u32 s48, s44, 4
  s_and_b32 s48, s48, 3
  s_lshl_b32 s48, s48, 15
  v_xor_b32 v72, 0x10000, v72
  v_xor_b32 v76, 0x10000, v76
  v_xor_b32 v77, 0x10000, v77
  v_xor_b32 v73, 0x10000, v73
  v_xor_b32 v78, 0x10000, v78
  v_xor_b32 v79, 0x10000, v79
  ds_read_b128 v[128:131], v72 offset:0
  ds_read_b64_tr_b16 v[144:145], v76 offset:0
  ds_read_b64_tr_b16 v[146:147], v76 offset:1024
  ds_read_b64_tr_b16 v[148:149], v77 offset:0
  ds_read_b64_tr_b16 v[150:151], v77 offset:1024
  s_cmp_eq_u32 s40, 2
  s_cbranch_scc0 P1_nd_15
  s_add_u32 m0, s43, s48
  s_nop 0
  buffer_load_dwordx4 v84, s[8:11], s41 offen lds
  buffer_load_dwordx4 v85, s[8:11], s41 offen offset:1024 lds
  s_add_u32 s41, s41, 128
P1_nd_15:
  s_waitcnt lgkmcnt(5)
  v_mfma_f32_32x32x16_bf16 v[16:31], v[168:171], v[140:143], v[16:31]
  v_mfma_f32_32x32x16_bf16 v[32:47], v[172:175], v[140:143], v[32:47]
  ds_read_b128 v[132:135], v73 offset:0
  ds_read_b64_tr_b16 v[152:153], v78 offset:0
  ds_read_b64_tr_b16 v[154:155], v78 offset:1024
  ds_read_b64_tr_b16 v[156:157], v79 offset:0
  ds_read_b64_tr_b16 v[158:159], v79 offset:1024
  s_cmp_eq_u32 s40, 2
  s_cbranch_scc0 P1_nd_16
  s_add_u32 m0, m0, 16384
  s_nop 0
  buffer_load_dwordx4 v86, s[12:15], s42 offen lds
  buffer_load_dwordx4 v87, s[12:15], s42 offen offset:1024 lds
  s_add_u32 s42, s42, 245760
P1_nd_16:
  s_add_u32 s44, s44, 2
  s_cmp_lt_u32 s44, 10
  s_cbranch_scc1 P1_loop_5
  s_waitcnt lgkmcnt(0)
  v_and_b32 v8, 31, v1
  v_lshrrev_b32 v9, 5, v1
  s_lshl_b32 s45, s39, 9
  s_lshl_b32 s46, s38, 8
  s_add_u32 s45, s45, s46
  s_add_u32 s45, s45, 131072
  v_lshlrev_b32 v3, 2, v1
  v_add_u32 v3, s45, v3
  s_mov_b64 exec, 0xffff
  ds_write_b32 v3, v100 offset:0
  ds_write_b32 v3, v101 offset:64
  ds_write_b32 v3, v104 offset:128
  ds_write_b32 v3, v105 offset:192
  s_mov_b64 exec, -1
  s_waitcnt lgkmcnt(0)
  s_barrier
  s_lshl_b32 s45, s38, 8
  s_add_u32 s45, s45, 131072
  v_lshlrev_b32 v3, 2, v1
  v_add_u32 v3, s45, v3
  ds_read_b32 v128, v3 offset:0
  ds_read_b32 v129, v3 offset:512
  ds_read_b32 v130, v3 offset:1024
  ds_read_b32 v131, v3 offset:1536
  s_waitcnt lgkmcnt(0)
  v_add_f32 v128, v128, v129
  v_add_f32 v130, v130, v131
  v_add_f32 v128, v128, v130
  s_lshl_b32 s45, s32, 8
  s_add_u32 s45, s45, 133120
  v_lshlrev_b32 v3, 2, v1
  v_add_u32 v3, s45, v3
  ds_write_b32 v3, v128
  v_lshlrev_b32 v3, 4, v9
  v_add_u32 v3, s45, v3
  s_waitcnt lgkmcnt(0)
  ds_read_b128 v[144:147], v3 offset:0
  ds_read_b128 v[148:151], v3 offset:32
  ds_read_b128 v[152:155], v3 offset:64
  ds_read_b128 v[156:159], v3 offset:96
  ds_read_b128 v[160:163], v3 offset:128
  ds_read_b128 v[164:167], v3 offset:160
  ds_read_b128 v[168:171], v3 offset:192
  ds_read_b128 v[172:175], v3 offset:224
  s_mov_b32 s50, 0
P1_gr_17:
  s_waitcnt vmcnt(0)
  v_cmp_ne_u32 vcc, s35, v93
  s_mov_b64 s[56:57], vcc
  v_cmp_ne_u32 vcc, s35, v95
  s_or_b64 vcc, vcc, s[56:57]
  s_cmp_eq_u64 vcc, 0
  s_cbranch_scc1 P1_grok_18
  s_add_u32 s50, s50, 1
  s_cmp_lt_u32 s50, 1048576
  s_cbranch_scc0 P1_grok_18
  buffer_load_dwordx4 v[92:95], v56, s[4:7], s75 offen sc1
  s_branch P1_gr_17
P1_grok_18:
  s_cmp_lt_u32 s36, 5
  s_cselect_b32 s46, 0x3ea52b5c, 1.0
  v_mul_f32 v93, s46, v94
  s_waitcnt lgkmcnt(0)
  v_sub_f32 v48, 0, v92
  v_sub_f32 v49, 0, v92
  v_mov_b32 v50, v93
  v_mov_b32 v51, v93
  v_pk_fma_f32 v[16:17], v[48:49], v[144:145], v[16:17]
  v_pk_fma_f32 v[18:19], v[48:49], v[146:147], v[18:19]
  v_pk_fma_f32 v[20:21], v[48:49], v[148:149], v[20:21]
  v_pk_fma_f32 v[22:23], v[48:49], v[150:151], v[22:23]
  v_pk_fma_f32 v[24:25], v[48:49], v[152:153], v[24:25]
  v_pk_fma_f32 v[26:27], v[48:49], v[154:155], v[26:27]
  v_pk_fma_f32 v[28:29], v[48:49], v[156:157], v[28:29]
  v_pk_fma_f32 v[30:31], v[48:49], v[158:159], v[30:31]
  v_pk_fma_f32 v[32:33], v[48:49], v[160:161], v[32:33]
  v_pk_fma_f32 v[34:35], v[48:49], v[162:163], v[34:35]
  v_pk_fma_f32 v[36:37], v[48:49], v[164:165], v[36:37]
  v_pk_fma_f32 v[38:39], v[48:49], v[166:167], v[38:39]
  v_pk_fma_f32 v[40:41], v[48:49], v[168:169], v[40:41]
  v_pk_fma_f32 v[42:43], v[48:49], v[170:171], v[42:43]
  v_pk_fma_f32 v[44:45], v[48:49], v[172:173], v[44:45]
  v_pk_fma_f32 v[46:47], v[48:49], v[174:175], v[46:47]
  v_pk_mul_f32 v[16:17], v[50:51], v[16:17]
  v_pk_mul_f32 v[18:19], v[50:51], v[18:19]
  v_pk_mul_f32 v[20:21], v[50:51], v[20:21]
  v_pk_mul_f32 v[22:23], v[50:51], v[22:23]
  v_pk_mul_f32 v[24:25], v[50:51], v[24:25]
  v_pk_mul_f32 v[26:27], v[50:51], v[26:27]
  v_pk_mul_f32 v[28:29], v[50:51], v[28:29]
  v_pk_mul_f32 v[30:31], v[50:51], v[30:31]
  v_pk_mul_f32 v[32:33], v[50:51], v[32:33]
  v_pk_mul_f32 v[34:35], v[50:51], v[34:35]
  v_pk_mul_f32 v[36:37], v[50:51], v[36:37]
  v_pk_mul_f32 v[38:39], v[50:51], v[38:39]
  v_pk_mul_f32 v[40:41], v[50:51], v[40:41]
  v_pk_mul_f32 v[42:43], v[50:51], v[42:43]
  v_pk_mul_f32 v[44:45], v[50:51], v[44:45]
  v_pk_mul_f32 v[46:47], v[50:51], v[46:47]
  v_cvt_pk_bf16_f32 v112, v16, v17
  v_cvt_pk_bf16_f32 v113, v18, v19
  v_cvt_pk_bf16_f32 v114, v20, v21
  v_cvt_pk_bf16_f32 v115, v22, v23
  v_cvt_pk_bf16_f32 v116, v24, v25
  v_cvt_pk_bf16_f32 v117, v26, v27
  v_cvt_pk_bf16_f32 v118, v28, v29
  v_cvt_pk_bf16_f32 v119, v30, v31
  v_cvt_pk_bf16_f32 v120, v32, v33
  v_cvt_pk_bf16_f32 v121, v34, v35
  v_cvt_pk_bf16_f32 v122, v36, v37
  v_cvt_pk_bf16_f32 v123, v38, v39
  v_cvt_pk_bf16_f32 v124, v40, v41
  v_cvt_pk_bf16_f32 v125, v42, v43
  v_cvt_pk_bf16_f32 v126, v44, v45
  v_cvt_pk_bf16_f32 v127, v46, v47
  s_cmp_lt_u32 s36, 5
  s_mov_b32 s45, 2560
  s_mov_b32 s50, 2756608
  s_cselect_b32 s45, 1280, s45
  s_cselect_b32 s50, 135168, s50
  s_cselect_b32 s53, 0, 1
  s_cselect_b32 s46, 0, 160
  s_lshl_b32 s51, s45, 6
  s_lshl_b32 s52, s36, 5
  s_sub_u32 s52, s52, s46
  s_lshl_b32 s46, s38, 4
  s_add_u32 s52, s52, s46
  s_lshl_b32 s47, s37, 2
  s_add_u32 s47, s47, s39
  s_mul_i32 s46, s47, s45
  s_add_u32 s50, s50, s46
  s_lshl_b32 s54, s47, 7
  s_add_u32 s54, s54, 8003584
  v_lshlrev_b32 v2, 4, v8
  v_lshlrev_b32 v3, 3, v8
  v_add_u32 v3, 1024, v3
  s_add_u32 s45, s52, 0
  v_add_u32 v92, s45, v9
  v_mul_u32_u24 v93, 205, v92
  v_lshrrev_b32 v93, 10, v93
  v_mul_u32_u24 v94, 5, v93
  v_sub_u32 v94, v92, v94
  v_and_b32 v4, 1, v93
  v_lshl_add_u32 v4, v4, 2, v94
  v_subrev_u32 v5, 5, v4
  v_min_u32 v94, v4, v5
  v_lshrrev_b32 v95, 1, v94
  v_lshl_add_u32 v95, v95, 9, v2
  v_and_b32 v4, 1, v94
  v_lshl_add_u32 v95, v4, 3, v95
  v_cmp_eq_u32 vcc, 4, v94
  v_mul_lo_u32 v5, v93, s51
  s_nop 0
  v_cndmask_b32 v95, v95, v3, vcc
  v_add_u32 v95, v95, v5
  s_mul_i32 s55, s45, 6554
  s_lshr_b32 s55, s55, 16
  s_mul_i32 s55, s55, 10
  s_sub_u32 s55, s45, s55
  s_cmp_eq_u32 s55, 4
  s_cbranch_scc1 P1_kb_19
  v_mov_b32 v16, v112
  v_mov_b32 v17, v113
  s_nop 1
  v_permlane32_swap_b32 v16, v18
  v_permlane32_swap_b32 v17, v19
  s_mov_b64 exec, 0xffffffff
  buffer_store_dwordx4 v[16:19], v95, s[4:7], s50 offen sc1
  s_mov_b64 exec, -1
  s_branch P1_ke_20
P1_kb_19:
  buffer_store_dwordx2 v[112:113], v95, s[4:7], s50 offen sc1
P1_ke_20:
  s_add_u32 s45, s52, 2
  v_add_u32 v92, s45, v9
  v_mul_u32_u24 v93, 205, v92
  v_lshrrev_b32 v93, 10, v93
  v_mul_u32_u24 v94, 5, v93
  v_sub_u32 v94, v92, v94
  v_and_b32 v4, 1, v93
  v_lshl_add_u32 v4, v4, 2, v94
  v_subrev_u32 v5, 5, v4
  v_min_u32 v94, v4, v5
  v_lshrrev_b32 v95, 1, v94
  v_lshl_add_u32 v95, v95, 9, v2
  v_and_b32 v4, 1, v94
  v_lshl_add_u32 v95, v4, 3, v95
  v_cmp_eq_u32 vcc, 4, v94
  v_mul_lo_u32 v5, v93, s51
  s_nop 0
  v_cndmask_b32 v95, v95, v3, vcc
  v_add_u32 v95, v95, v5
  s_mul_i32 s55, s45, 6554
  s_lshr_b32 s55, s55, 16
  s_mul_i32 s55, s55, 10
  s_sub_u32 s55, s45, s55
  s_cmp_eq_u32 s55, 4
  s_cbranch_scc1 P1_kb_21
  v_mov_b32 v20, v114
  v_mov_b32 v21, v115
  s_nop 1
  v_permlane32_swap_b32 v20, v22
  v_permlane32_swap_b32 v21, v23
  s_mov_b64 exec, 0xffffffff
  buffer_store_dwordx4 v[20:23], v95, s[4:7], s50 offen sc1
  s_mov_b64 exec, -1
  s_branch P1_ke_22
P1_kb_21:
  buffer_store_dwordx2 v[114:115], v95, s[4:7], s50 offen sc1
P1_ke_22:
  s_add_u32 s45, s52, 4
  v_add_u32 v92, s45, v9
  v_mul_u32_u24 v93, 205, v92
  v_lshrrev_b32 v93, 10, v93
  v_mul_u32_u24 v94, 5, v93
  v_sub_u32 v94, v92, v94
  v_and_b32 v4, 1, v93
  v_lshl_add_u32 v4, v4, 2, v94
  v_subrev_u32 v5, 5, v4
  v_min_u32 v94, v4, v5
  v_lshrrev_b32 v95, 1, v94
  v_lshl_add_u32 v95, v95, 9, v2
  v_and_b32 v4, 1, v94
  v_lshl_add_u32 v95, v4, 3, v95
  v_cmp_eq_u32 vcc, 4, v94
  v_mul_lo_u32 v5, v93, s51
  s_nop 0
  v_cndmask_b32 v95, v95, v3, vcc
  v_add_u32 v95, v95, v5
  s_mul_i32 s55, s45, 6554
  s_lshr_b32 s55, s55, 16
  s_mul_i32 s55, s55, 10
  s_sub_u32 s55, s45, s55
  s_cmp_eq_u32 s55, 4
  s_cbranch_scc1 P1_kb_23
  v_mov_b32 v24, v116
  v_mov_b32 v25, v117
  s_nop 1
  v_permlane32_swap_b32 v24, v26
  v_permlane32_swap_b32 v25, v27
  s_mov_b64 exec, 0xffffffff
  buffer_store_dwordx4 v[24:27], v95, s[4:7], s50 offen sc1
  s_mov_b64 exec, -1
  s_branch P1_ke_24
P1_kb_23:
  buffer_store_dwordx2 v[116:117], v95, s[4:7], s50 offen sc1
P1_ke_24:
  s_add_u32 s45, s52, 6
  v_add_u32 v92, s45, v9
  v_mul_u32_u24 v93, 205, v92
  v_lshrrev_b32 v93, 10, v93
  v_mul_u32_u24 v94, 5, v93
  v_sub_u32 v94, v92, v94
  v_and_b32 v4, 1, v93
  v_lshl_add_u32 v4, v4, 2, v94
  v_subrev_u32 v5, 5, v4
  v_min_u32 v94, v4, v5
  v_lshrrev_b32 v95, 1, v94
  v_lshl_add_u32 v95, v95, 9, v2
  v_and_b32 v4, 1, v94
  v_lshl_add_u32 v95, v4, 3, v95
  v_cmp_eq_u32 vcc, 4, v94
  v_mul_lo_u32 v5, v93, s51
  s_nop 0
  v_cndmask_b32 v95, v95, v3, vcc
  v_add_u32 v95, v95, v5
  s_mul_i32 s55, s45, 6554
  s_lshr_b32 s55, s55, 16
  s_mul_i32 s55, s55, 10
  s_sub_u32 s55, s45, s55
  s_cmp_eq_u32 s55, 4
  s_cbranch_scc1 P1_kb_25
  v_mov_b32 v28, v118
  v_mov_b32 v29, v119
  s_nop 1
  v_permlane32_swap_b32 v28, v30
  v_permlane32_swap_b32 v29, v31
  s_mov_b64 exec, 0xffffffff
  buffer_store_dwordx4 v[28:31], v95, s[4:7], s50 offen sc1
  s_mov_b64 exec, -1
  s_branch P1_ke_26
P1_kb_25:
  buffer_store_dwordx2 v[118:119], v95, s[4:7], s50 offen sc1
P1_ke_26:
  s_add_u32 s45, s52, 8
  v_add_u32 v92, s45, v9
  v_mul_u32_u24 v93, 205, v92
  v_lshrrev_b32 v93, 10, v93
  v_mul_u32_u24 v94, 5, v93
  v_sub_u32 v94, v92, v94
  v_and_b32 v4, 1, v93
  v_lshl_add_u32 v4, v4, 2, v94
  v_subrev_u32 v5, 5, v4
  v_min_u32 v94, v4, v5
  v_lshrrev_b32 v95, 1, v94
  v_lshl_add_u32 v95, v95, 9, v2
  v_and_b32 v4, 1, v94
  v_lshl_add_u32 v95, v4, 3, v95
  v_cmp_eq_u32 vcc, 4, v94
  v_mul_lo_u32 v5, v93, s51
  s_nop 0
  v_cndmask_b32 v95, v95, v3, vcc
  v_add_u32 v95, v95, v5
  s_mul_i32 s55, s45, 6554
  s_lshr_b32 s55, s55, 16
  s_mul_i32 s55, s55, 10
  s_sub_u32 s55, s45, s55
  s_cmp_eq_u32 s55, 4
  s_cbranch_scc1 P1_kb_27
  v_mov_b32 v16, v120
  v_mov_b32 v17, v121
  s_nop 1
  v_permlane32_swap_b32 v16, v18
  v_permlane32_swap_b32 v17, v19
  s_mov_b64 exec, 0xffffffff
  buffer_store_dwordx4 v[16:19], v95, s[4:7], s50 offen sc1
  s_mov_b64 exec, -1
  s_branch P1_ke_28
P1_kb_27:
  buffer_store_dwordx2 v[120:121], v95, s[4:7], s50 offen sc1
P1_ke_28:
  s_add_u32 s45, s52, 10
  v_add_u32 v92, s45, v9
  v_mul_u32_u24 v93, 205, v92
  v_lshrrev_b32 v93, 10, v93
  v_mul_u32_u24 v94, 5, v93
  v_sub_u32 v94, v92, v94
  v_and_b32 v4, 1, v93
  v_lshl_add_u32 v4, v4, 2, v94
  v_subrev_u32 v5, 5, v4
  v_min_u32 v94, v4, v5
  v_lshrrev_b32 v95, 1, v94
  v_lshl_add_u32 v95, v95, 9, v2
  v_and_b32 v4, 1, v94
  v_lshl_add_u32 v95, v4, 3, v95
  v_cmp_eq_u32 vcc, 4, v94
  v_mul_lo_u32 v5, v93, s51
  s_nop 0
  v_cndmask_b32 v95, v95, v3, vcc
  v_add_u32 v95, v95, v5
  s_mul_i32 s55, s45, 6554
  s_lshr_b32 s55, s55, 16
  s_mul_i32 s55, s55, 10
  s_sub_u32 s55, s45, s55
  s_cmp_eq_u32 s55, 4
  s_cbranch_scc1 P1_kb_29
  v_mov_b32 v20, v122
  v_mov_b32 v21, v123
  s_nop 1
  v_permlane32_swap_b32 v20, v22
  v_permlane32_swap_b32 v21, v23
  s_mov_b64 exec, 0xffffffff
  buffer_store_dwordx4 v[20:23], v95, s[4:7], s50 offen sc1
  s_mov_b64 exec, -1
  s_branch P1_ke_30
P1_kb_29:
  buffer_store_dwordx2 v[122:123], v95, s[4:7], s50 offen sc1
P1_ke_30:
  s_add_u32 s45, s52, 12
  v_add_u32 v92, s45, v9
  v_mul_u32_u24 v93, 205, v92
  v_lshrrev_b32 v93, 10, v93
  v_mul_u32_u24 v94, 5, v93
  v_sub_u32 v94, v92, v94
  v_and_b32 v4, 1, v93
  v_lshl_add_u32 v4, v4, 2, v94
  v_subrev_u32 v5, 5, v4
  v_min_u32 v94, v4, v5
  v_lshrrev_b32 v95, 1, v94
  v_lshl_add_u32 v95, v95, 9, v2
  v_and_b32 v4, 1, v94
  v_lshl_add_u32 v95, v4, 3, v95
  v_cmp_eq_u32 vcc, 4, v94
  v_mul_lo_u32 v5, v93, s51
  s_nop 0
  v_cndmask_b32 v95, v95, v3, vcc
  v_add_u32 v95, v95, v5
  s_mul_i32 s55, s45, 6554
  s_lshr_b32 s55, s55, 16
  s_mul_i32 s55, s55, 10
  s_sub_u32 s55, s45, s55
  s_cmp_eq_u32 s55, 4
  s_cbranch_scc1 P1_kb_31
  v_mov_b32 v24, v124
  v_mov_b32 v25, v125
  s_nop 1
  v_permlane32_swap_b32 v24, v26
  v_permlane32_swap_b32 v25, v27
  s_mov_b64 exec, 0xffffffff
  buffer_store_dwordx4 v[24:27], v95, s[4:7], s50 offen sc1
  s_mov_b64 exec, -1
  s_branch P1_ke_32
P1_kb_31:
  buffer_store_dwordx2 v[124:125], v95, s[4:7], s50 offen sc1
P1_ke_32:
  s_add_u32 s45, s52, 14
  v_add_u32 v92, s45, v9
  v_mul_u32_u24 v93, 205, v92
  v_lshrrev_b32 v93, 10, v93
  v_mul_u32_u24 v94, 5, v93
  v_sub_u32 v94, v92, v94
  v_and_b32 v4, 1, v93
  v_lshl_add_u32 v4, v4, 2, v94
  v_subrev_u32 v5, 5, v4
  v_min_u32 v94, v4, v5
  v_lshrrev_b32 v95, 1, v94
  v_lshl_add_u32 v95, v95, 9, v2
  v_and_b32 v4, 1, v94
  v_lshl_add_u32 v95, v4, 3, v95
  v_cmp_eq_u32 vcc, 4, v94
  v_mul_lo_u32 v5, v93, s51
  s_nop 0
  v_cndmask_b32 v95, v95, v3, vcc
  v_add_u32 v95, v95, v5
  s_mul_i32 s55, s45, 6554
  s_lshr_b32 s55, s55, 16
  s_mul_i32 s55, s55, 10
  s_sub_u32 s55, s45, s55
  s_cmp_eq_u32 s55, 4
  s_cbranch_scc1 P1_kb_33
  v_mov_b32 v28, v126
  v_mov_b32 v29, v127
  s_nop 1
  v_permlane32_swap_b32 v28, v30
  v_permlane32_swap_b32 v29, v31
  s_mov_b64 exec, 0xffffffff
  buffer_store_dwordx4 v[28:31], v95, s[4:7], s50 offen sc1
  s_mov_b64 exec, -1
  s_branch P1_ke_34
P1_kb_33:
  buffer_store_dwordx2 v[126:127], v95, s[4:7], s50 offen sc1
P1_ke_34:
  s_cmp_eq_u32 s53, 0
  s_cbranch_scc1 P1_nok_35
  v_mov_b32 v96, 0
  v_mov_b32 v97, 0
  v_mov_b32 v98, 0
  v_mov_b32 v99, 0
  v_mov_b32 v100, 0
  v_mov_b32 v101, 0
  v_mov_b32 v102, 0
  v_mov_b32 v103, 0
  v_dot2c_f32_bf16 v96, v112, v112
  v_dot2c_f32_bf16 v97, v114, v114
  v_dot2c_f32_bf16 v98, v116, v116
  v_dot2c_f32_bf16 v99, v118, v118
  v_dot2c_f32_bf16 v100, v120, v120
  v_dot2c_f32_bf16 v101, v122, v122
  v_dot2c_f32_bf16 v102, v124, v124
  v_dot2c_f32_bf16 v103, v126, v126
  v_dot2c_f32_bf16 v96, v113, v113
  v_dot2c_f32_bf16 v97, v115, v115
  v_dot2c_f32_bf16 v98, v117, v117
  v_dot2c_f32_bf16 v99, v119, v119
  v_dot2c_f32_bf16 v100, v121, v121
  v_dot2c_f32_bf16 v101, v123, v123
  v_dot2c_f32_bf16 v102, v125, v125
  v_dot2c_f32_bf16 v103, v127, v127
  s_nop 2
  v_max3_f32 v96, v96, v97, v98
  v_max3_f32 v99, v99, v100, v101
  v_max3_f32 v96, v96, v102, v103
  v_max_f32 v96, v96, v99
  s_nop 1
  v_max_f32_dpp v96, v96, v96 row_shr:1 row_mask:0xf bank_mask:0xf
  s_nop 1
  v_max_f32_dpp v96, v96, v96 row_shr:2 row_mask:0xf bank_mask:0xf
  s_nop 1
  v_max_f32_dpp v96, v96, v96 row_shr:4 row_mask:0xf bank_mask:0xf
  s_nop 1
  v_max_f32_dpp v96, v96, v96 row_shr:8 row_mask:0xf bank_mask:0xf
  s_nop 1
  v_max_f32_dpp v96, v96, v96 row_bcast:15 row_mask:0xa bank_mask:0xf
  s_nop 1
  v_max_f32_dpp v96, v96, v96 row_bcast:31 row_mask:0xc bank_mask:0xf
  s_sub_u32 s45, s36, 5
  s_lshl_b32 s45, s45, 1
  s_add_u32 s45, s45, s38
  s_lshl_b32 s45, s45, 13
  s_add_u32 s54, s54, s45
  v_readlane_b32 s55, v96, 63
  v_lshlrev_b32 v2, 4, v1
  s_nop 2
  v_mov_b32 v96, s55
  v_mov_b32 v97, s55
  v_mov_b32 v98, s55
  v_mov_b32 v99, s55
  s_mov_b64 exec, 0xff
  buffer_store_dwordx4 v[96:99], v2, s[4:7], s54 offen sc1
  s_mov_b64 exec, -1
P1_nok_35:
  s_branch P1_end_3
P1_vtype_4:
P1_loop_36:
  s_waitcnt lgkmcnt(5)
  v_mfma_f32_32x32x16_bf16 v[16:31], v[128:131], v[144:147], v[16:31]
  v_mfma_f32_32x32x16_bf16 v[32:47], v[128:131], v[148:151], v[32:47]
  ds_read_b128 v[136:139], v74 offset:0
  ds_read_b64_tr_b16 v[160:161], v80 offset:0
  ds_read_b64_tr_b16 v[162:163], v80 offset:1024
  ds_read_b64_tr_b16 v[164:165], v81 offset:0
  ds_read_b64_tr_b16 v[166:167], v81 offset:1024
  v_mfma_f32_16x16x32_bf16 v[100:103], v[108:111], v[144:147], v[100:103]
  v_mfma_f32_16x16x32_bf16 v[104:107], v[108:111], v[148:151], v[104:107]
  s_cmp_eq_u32 s40, 1
  s_cbranch_scc0 P1_nd_37
  s_add_u32 m0, s43, s48
  s_nop 0
  buffer_load_dwordx4 v84, s[8:11], s41 offen lds
  buffer_load_dwordx4 v85, s[8:11], s41 offen offset:1024 lds
  s_add_u32 s41, s41, 128
P1_nd_37:
  s_waitcnt lgkmcnt(5)
  v_mfma_f32_32x32x16_bf16 v[16:31], v[132:135], v[152:155], v[16:31]
  v_mfma_f32_32x32x16_bf16 v[32:47], v[132:135], v[156:159], v[32:47]
  ds_read_b128 v[140:143], v75 offset:0
  ds_read_b64_tr_b16 v[168:169], v82 offset:0
  ds_read_b64_tr_b16 v[170:171], v82 offset:1024
  ds_read_b64_tr_b16 v[172:173], v83 offset:0
  ds_read_b64_tr_b16 v[174:175], v83 offset:1024
  s_cmp_eq_u32 s40, 1
  s_cbranch_scc0 P1_nd_38
  s_add_u32 m0, m0, 16384
  s_nop 0
  buffer_load_dwordx4 v86, s[12:15], s42 offen lds
  buffer_load_dwordx4 v87, s[12:15], s42 offen offset:1024 lds
  s_add_u32 s42, s42, 245760
P1_nd_38:
  s_waitcnt lgkmcnt(5)
  v_mfma_f32_32x32x16_bf16 v[16:31], v[136:139], v[160:163], v[16:31]
  s_waitcnt vmcnt(4)
  s_cmp_lt_u32 s44, 8
  s_cbranch_scc1 P1_z_39
  s_waitcnt vmcnt(0)
P1_z_39:
  s_barrier
  v_mfma_f32_32x32x16_bf16 v[32:47], v[136:139], v[164:167], v[32:47]
  s_cmp_lt_u32 s44, 7
  s_cselect_b32 s40, s49, 0
  s_add_u32 s48, s44, 3
  s_and_b32 s48, s48, 3
  s_lshl_b32 s48, s48, 15
  ds_read_b128 v[128:131], v72 offset:32768
  ds_read_b64_tr_b16 v[144:145], v76 offset:32768
  ds_read_b64_tr_b16 v[146:147], v76 offset:33792
  ds_read_b64_tr_b16 v[148:149], v77 offset:32768
  ds_read_b64_tr_b16 v[150:151], v77 offset:33792
  s_cmp_eq_u32 s40, 2
  s_cbranch_scc0 P1_nd_40
  s_add_u32 m0, s43, s48
  s_nop 0
  buffer_load_dwordx4 v84, s[8:11], s41 offen lds
  buffer_load_dwordx4 v85, s[8:11], s41 offen offset:1024 lds
  s_add_u32 s41, s41, 128
P1_nd_40:
  s_waitcnt lgkmcnt(5)
  v_mfma_f32_32x32x16_bf16 v[16:31], v[140:143], v[168:171], v[16:31]
  v_mfma_f32_32x32x16_bf16 v[32:47], v[140:143], v[172:175], v[32:47]
  s_cmp_eq_u32 s44, 8
  s_cbranch_scc0 P1_gl_41
  buffer_load_dwordx4 v[92:95], v56, s[4:7], s75 offen sc1
P1_gl_41:
  ds_read_b128 v[132:135], v73 offset:32768
  ds_read_b64_tr_b16 v[152:153], v78 offset:32768
  ds_read_b64_tr_b16 v[154:155], v78 offset:33792
  ds_read_b64_tr_b16 v[156:157], v79 offset:32768
  ds_read_b64_tr_b16 v[158:159], v79 offset:33792
  s_cmp_eq_u32 s40, 2
  s_cbranch_scc0 P1_nd_42
  s_add_u32 m0, m0, 16384
  s_nop 0
  buffer_load_dwordx4 v86, s[12:15], s42 offen lds
  buffer_load_dwordx4 v87, s[12:15], s42 offen offset:1024 lds
  s_add_u32 s42, s42, 245760
P1_nd_42:
  s_waitcnt lgkmcnt(5)
  v_mfma_f32_32x32x16_bf16 v[16:31], v[128:131], v[144:147], v[16:31]
  v_mfma_f32_32x32x16_bf16 v[32:47], v[128:131], v[148:151], v[32:47]
  ds_read_b128 v[136:139], v74 offset:32768
  ds_read_b64_tr_b16 v[160:161], v80 offset:32768
  ds_read_b64_tr_b16 v[162:163], v80 offset:33792
  ds_read_b64_tr_b16 v[164:165], v81 offset:32768
  ds_read_b64_tr_b16 v[166:167], v81 offset:33792
  v_mfma_f32_16x16x32_bf16 v[100:103], v[108:111], v[144:147], v[100:103]
  v_mfma_f32_16x16x32_bf16 v[104:107], v[108:111], v[148:151], v[104:107]
  s_cmp_eq_u32 s40, 1
  s_cbranch_scc0 P1_nd_43
  s_add_u32 m0, s43, s48
  s_nop 0
  buffer_load_dwordx4 v84, s[8:11], s41 offen lds
  buffer_load_dwordx4 v85, s[8:11], s41 offen offset:1024 lds
  s_add_u32 s41, s41, 128
P1_nd_43:
  s_waitcnt lgkmcnt(5)
  v_mfma_f32_32x32x16_bf16 v[16:31], v[132:135], v[152:155], v[16:31]
  v_mfma_f32_32x32x16_bf16 v[32:47], v[132:135], v[156:159], v[32:47]
  ds_read_b128 v[140:143], v75 offset:32768
  ds_read_b64_tr_b16 v[168:169], v82 offset:32768
  ds_read_b64_tr_b16 v[170:171], v82 offset:33792
  ds_read_b64_tr_b16 v[172:173], v83 offset:32768
  ds_read_b64_tr_b16 v[174:175], v83 offset:33792
  v_xor_b32 v74, 0x10000, v74
  v_xor_b32 v80, 0x10000, v80
  v_xor_b32 v81, 0x10000, v81
  v_xor_b32 v75, 0x10000, v75
  v_xor_b32 v82, 0x10000, v82
  v_xor_b32 v83, 0x10000, v83
  s_cmp_eq_u32 s40, 1
  s_cbranch_scc0 P1_nd_44
  s_add_u32 m0, m0, 16384
  s_nop 0
  buffer_load_dwordx4 v86, s[12:15], s42 offen lds
  buffer_load_dwordx4 v87, s[12:15], s42 offen offset:1024 lds
  s_add_u32 s42, s42, 245760
P1_nd_44:
  s_waitcnt lgkmcnt(5)
  v_mfma_f32_32x32x16_bf16 v[16:31], v[136:139], v[160:163], v[16:31]
  s_waitcnt vmcnt(4)
  s_cmp_lt_u32 s44, 7
  s_cbranch_scc1 P1_z_45
  s_waitcnt vmcnt(0)
P1_z_45:
  s_barrier
  v_mfma_f32_32x32x16_bf16 v[32:47], v[136:139], v[164:167], v[32:47]
  s_cmp_lt_u32 s44, 6
  s_cselect_b32 s40, s49, 0
  s_add_u32 s48, s44, 4
  s_and_b32 s48, s48, 3
  s_lshl_b32 s48, s48, 15
  v_xor_b32 v72, 0x10000, v72
  v_xor_b32 v76, 0x10000, v76
  v_xor_b32 v77, 0x10000, v77
  v_xor_b32 v73, 0x10000, v73
  v_xor_b32 v78, 0x10000, v78
  v_xor_b32 v79, 0x10000, v79
  ds_read_b128 v[128:131], v72 offset:0
  ds_read_b64_tr_b16 v[144:145], v76 offset:0
  ds_read_b64_tr_b16 v[146:147], v76 offset:1024
  ds_read_b64_tr_b16 v[148:149], v77 offset:0
  ds_read_b64_tr_b16 v[150:151], v77 offset:1024
  s_cmp_eq_u32 s40, 2
  s_cbranch_scc0 P1_nd_46
  s_add_u32 m0, s43, s48
  s_nop 0
  buffer_load_dwordx4 v84, s[8:11], s41 offen lds
  buffer_load_dwordx4 v85, s[8:11], s41 offen offset:1024 lds
  s_add_u32 s41, s41, 128
P1_nd_46:
  s_waitcnt lgkmcnt(5)
  v_mfma_f32_32x32x16_bf16 v[16:31], v[140:143], v[168:171], v[16:31]
  v_mfma_f32_32x32x16_bf16 v[32:47], v[140:143], v[172:175], v[32:47]
  ds_read_b128 v[132:135], v73 offset:0
  ds_read_b64_tr_b16 v[152:153], v78 offset:0
  ds_read_b64_tr_b16 v[154:155], v78 offset:1024
  ds_read_b64_tr_b16 v[156:157], v79 offset:0
  ds_read_b64_tr_b16 v[158:159], v79 offset:1024
  s_cmp_eq_u32 s40, 2
  s_cbranch_scc0 P1_nd_47
  s_add_u32 m0, m0, 16384
  s_nop 0
  buffer_load_dwordx4 v86, s[12:15], s42 offen lds
  buffer_load_dwordx4 v87, s[12:15], s42 offen offset:1024 lds
  s_add_u32 s42, s42, 245760
P1_nd_47:
  s_add_u32 s44, s44, 2
  s_cmp_lt_u32 s44, 10
  s_cbranch_scc1 P1_loop_36
  s_waitcnt lgkmcnt(0)
  v_and_b32 v8, 31, v1
  v_lshrrev_b32 v9, 5, v1
  s_lshl_b32 s45, s39, 9
  s_lshl_b32 s46, s38, 8
  s_add_u32 s45, s45, s46
  s_add_u32 s45, s45, 131072
  v_lshlrev_b32 v3, 2, v1
  v_add_u32 v3, s45, v3
  s_mov_b64 exec, 0xffff
  ds_write_b32 v3, v100 offset:0
  ds_write_b32 v3, v101 offset:64
  ds_write_b32 v3, v104 offset:128
  ds_write_b32 v3, v105 offset:192
  s_mov_b64 exec, -1
  s_waitcnt lgkmcnt(0)
  s_barrier
  s_lshl_b32 s45, s38, 8
  s_add_u32 s45, s45, 131072
  v_lshlrev_b32 v3, 2, v8
  v_add_u32 v3, s45, v3
  ds_read_b32 v128, v3 offset:0
  ds_read_b32 v129, v3 offset:512
  ds_read_b32 v130, v3 offset:1024
  ds_read_b32 v131, v3 offset:1536
  ds_read_b32 v132, v3 offset:128
  ds_read_b32 v133, v3 offset:640
  ds_read_b32 v134, v3 offset:1152
  ds_read_b32 v135, v3 offset:1664
  s_mov_b32 s50, 0
P1_gr_48:
  s_waitcnt vmcnt(0)
  v_cmp_ne_u32 vcc, s35, v93
  s_mov_b64 s[56:57], vcc
  v_cmp_ne_u32 vcc, s35, v95
  s_or_b64 vcc, vcc, s[56:57]
  s_cmp_eq_u64 vcc, 0
  s_cbranch_scc1 P1_grok_49
  s_add_u32 s50, s50, 1
  s_cmp_lt_u32 s50, 1048576
  s_cbranch_scc0 P1_grok_49
  buffer_load_dwordx4 v[92:95], v56, s[4:7], s75 offen sc1
  s_branch P1_gr_48
P1_grok_49:
  s_lshl_b32 s45, s32, 8
  s_add_u32 s45, s45, 133120
  v_lshlrev_b32 v3, 2, v8
  v_add_u32 v3, s45, v3
  s_mov_b64 exec, 0xffffffff
  ds_write_b32 v3, v92
  ds_write_b32 v3, v94 offset:128
  s_mov_b64 exec, -1
  v_lshlrev_b32 v3, 4, v9
  v_add_u32 v3, s45, v3
  s_waitcnt lgkmcnt(0)
  ds_read_b128 v[144:147], v3 offset:0
  ds_read_b128 v[160:163], v3 offset:128
  ds_read_b128 v[148:151], v3 offset:32
  ds_read_b128 v[164:167], v3 offset:160
  ds_read_b128 v[152:155], v3 offset:64
  ds_read_b128 v[168:171], v3 offset:192
  ds_read_b128 v[156:159], v3 offset:96
  ds_read_b128 v[172:175], v3 offset:224
  v_add_f32 v128, v128, v129
  v_add_f32 v130, v130, v131
  v_add_f32 v128, v128, v130
  v_add_f32 v132, v132, v133
  v_add_f32 v134, v134, v135
  v_add_f32 v132, v132, v134
  s_waitcnt lgkmcnt(0)
  v_sub_f32 v48, 0, v128
  v_sub_f32 v49, 0, v128
  v_pk_fma_f32 v[16:17], v[144:145], v[48:49], v[16:17]
  v_pk_fma_f32 v[18:19], v[146:147], v[48:49], v[18:19]
  v_pk_fma_f32 v[20:21], v[148:149], v[48:49], v[20:21]
  v_pk_fma_f32 v[22:23], v[150:151], v[48:49], v[22:23]
  v_pk_fma_f32 v[24:25], v[152:153], v[48:49], v[24:25]
  v_pk_fma_f32 v[26:27], v[154:155], v[48:49], v[26:27]
  v_pk_fma_f32 v[28:29], v[156:157], v[48:49], v[28:29]
  v_pk_fma_f32 v[30:31], v[158:159], v[48:49], v[30:31]
  v_pk_mul_f32 v[16:17], v[160:161], v[16:17]
  v_pk_mul_f32 v[18:19], v[162:163], v[18:19]
  v_pk_mul_f32 v[20:21], v[164:165], v[20:21]
  v_pk_mul_f32 v[22:23], v[166:167], v[22:23]
  v_pk_mul_f32 v[24:25], v[168:169], v[24:25]
  v_pk_mul_f32 v[26:27], v[170:171], v[26:27]
  v_pk_mul_f32 v[28:29], v[172:173], v[28:29]
  v_pk_mul_f32 v[30:31], v[174:175], v[30:31]
  v_cvt_pk_bf16_f32 v112, v16, v17
  v_cvt_pk_bf16_f32 v113, v18, v19
  v_cvt_pk_bf16_f32 v114, v20, v21
  v_cvt_pk_bf16_f32 v115, v22, v23
  v_cvt_pk_bf16_f32 v116, v24, v25
  v_cvt_pk_bf16_f32 v117, v26, v27
  v_cvt_pk_bf16_f32 v118, v28, v29
  v_cvt_pk_bf16_f32 v119, v30, v31
  v_sub_f32 v48, 0, v132
  v_sub_f32 v49, 0, v132
  v_pk_fma_f32 v[32:33], v[144:145], v[48:49], v[32:33]
  v_pk_fma_f32 v[34:35], v[146:147], v[48:49], v[34:35]
  v_pk_fma_f32 v[36:37], v[148:149], v[48:49], v[36:37]
  v_pk_fma_f32 v[38:39], v[150:151], v[48:49], v[38:39]
  v_pk_fma_f32 v[40:41], v[152:153], v[48:49], v[40:41]
  v_pk_fma_f32 v[42:43], v[154:155], v[48:49], v[42:43]
  v_pk_fma_f32 v[44:45], v[156:157], v[48:49], v[44:45]
  v_pk_fma_f32 v[46:47], v[158:159], v[48:49], v[46:47]
  v_pk_mul_f32 v[32:33], v[160:161], v[32:33]
  v_pk_mul_f32 v[34:35], v[162:163], v[34:35]
  v_pk_mul_f32 v[36:37], v[164:165], v[36:37]
  v_pk_mul_f32 v[38:39], v[166:167], v[38:39]
  v_pk_mul_f32 v[40:41], v[168:169], v[40:41]
  v_pk_mul_f32 v[42:43], v[170:171], v[42:43]
  v_pk_mul_f32 v[44:45], v[172:173], v[44:45]
  v_pk_mul_f32 v[46:47], v[174:175], v[46:47]
  v_cvt_pk_bf16_f32 v120, v32, v33
  v_cvt_pk_bf16_f32 v121, v34, v35
  v_cvt_pk_bf16_f32 v122, v36, v37
  v_cvt_pk_bf16_f32 v123, v38, v39
  v_cvt_pk_bf16_f32 v124, v40, v41
  v_cvt_pk_bf16_f32 v125, v42, v43
  v_cvt_pk_bf16_f32 v126, v44, v45
  v_cvt_pk_bf16_f32 v127, v46, v47
  s_sub_u32 s45, s36, 10
  s_lshl_b32 s45, s45, 7
  s_lshl_b32 s46, s38, 6
  s_add_u32 s45, s45, s46
  s_lshl_b32 s47, s37, 2
  s_add_u32 s47, s47, s39
  s_mul_i32 s50, s47, 2560
  s_add_u32 s50, s50, 2756608
  s_mov_b32 s51, 163840
  v_mul_u32_u24 v6, 320, v9
  v_mov_b32 v92, 0x3f803f80
  v_mov_b32 v93, 0x3f803f80
  v_mov_b32 v94, 0x3f803f80
  v_mov_b32 v95, 0x3f803f80
  v_mov_b32 v96, 0
  v_mov_b32 v97, 0
  v_mov_b32 v98, 0
  v_mov_b32 v99, 0
  v_mov_b32 v100, 0x3f803f80
  v_mov_b32 v101, 0x00003f80
  v_add_u32 v2, s45, v8
  v_add_u32 v2, 0, v2
  v_mul_u32_u24 v3, 3277, v2
  v_lshrrev_b32 v3, 16, v3
  v_mul_u32_u24 v4, 20, v3
  v_sub_u32 v4, v2, v4
  v_and_b32 v7, 1, v3
  v_lshl_add_u32 v7, v7, 4, v4
  v_subrev_u32 v5, 20, v7
  v_min_u32 v7, v7, v5
  v_mul_lo_u32 v3, v3, s51
  v_lshl_add_u32 v5, v7, 4, v3
  v_add_u32 v5, v5, v6
  buffer_store_dwordx4 v[112:115], v5, s[4:7], s50 offen offset:1280 sc1
  buffer_store_dwordx4 v[116:119], v5, s[4:7], s50 offen offset:1920 sc1
  v_add_u32 v2, s45, v8
  v_add_u32 v2, 32, v2
  v_mul_u32_u24 v3, 3277, v2
  v_lshrrev_b32 v3, 16, v3
  v_mul_u32_u24 v4, 20, v3
  v_sub_u32 v4, v2, v4
  v_and_b32 v7, 1, v3
  v_lshl_add_u32 v7, v7, 4, v4
  v_subrev_u32 v5, 20, v7
  v_min_u32 v7, v7, v5
  v_mul_lo_u32 v3, v3, s51
  v_lshl_add_u32 v5, v7, 4, v3
  v_add_u32 v5, v5, v6
  buffer_store_dwordx4 v[120:123], v5, s[4:7], s50 offen offset:1280 sc1
  buffer_store_dwordx4 v[124:127], v5, s[4:7], s50 offen offset:1920 sc1
  s_branch P1_end_3
P1_idle_2:
  s_waitcnt lgkmcnt(0)
  s_mul_i32 s35, s35, 0x9e3779b1
  s_add_u32 s35, s35, 0x7f4a7c15
  s_waitcnt vmcnt(0)
  v_mov_b32 v92, 0
  v_mov_b32 v93, 0
  v_lshlrev_b32 v94, 16, v176
  v_and_b32 v95, 0xffff0000, v176
  v_add_f32 v92, v92, v94
  v_fmac_f32 v93, v94, v94
  v_add_f32 v92, v92, v95
  v_fmac_f32 v93, v95, v95
  v_lshlrev_b32 v94, 16, v177
  v_and_b32 v95, 0xffff0000, v177
  v_add_f32 v92, v92, v94
  v_fmac_f32 v93, v94, v94
  v_add_f32 v92, v92, v95
  v_fmac_f32 v93, v95, v95
  v_lshlrev_b32 v94, 16, v178
  v_and_b32 v95, 0xffff0000, v178
  v_add_f32 v92, v92, v94
  v_fmac_f32 v93, v94, v94
  v_add_f32 v92, v92, v95
  v_fmac_f32 v93, v95, v95
  v_lshlrev_b32 v94, 16, v179
  v_and_b32 v95, 0xffff0000, v179
  v_add_f32 v92, v92, v94
  v_fmac_f32 v93, v94, v94
  v_add_f32 v92, v92, v95
  v_fmac_f32 v93, v95, v95
  v_lshlrev_b32 v94, 16, v180
  v_and_b32 v95, 0xffff0000, v180
  v_add_f32 v92, v92, v94
  v_fmac_f32 v93, v94, v94
  v_add_f32 v92, v92, v95
  v_fmac_f32 v93, v95, v95
  v_lshlrev_b32 v94, 16, v181
  v_and_b32 v95, 0xffff0000, v181
  v_add_f32 v92, v92, v94
  v_fmac_f32 v93, v94, v94
  v_add_f32 v92, v92, v95
  v_fmac_f32 v93, v95, v95
  v_lshlrev_b32 v94, 16, v182
  v_and_b32 v95, 0xffff0000, v182
  v_add_f32 v92, v92, v94
  v_fmac_f32 v93, v94, v94
  v_add_f32 v92, v92, v95
  v_fmac_f32 v93, v95, v95
  v_lshlrev_b32 v94, 16, v183
  v_and_b32 v95, 0xffff0000, v183
  v_add_f32 v92, v92, v94
  v_fmac_f32 v93, v94, v94
  v_add_f32 v92, v92, v95
  v_fmac_f32 v93, v95, v95
  s_nop 0
  v_add_f32_dpp v92, v92, v92 row_shr:1 row_mask:0xf bank_mask:0xf bound_ctrl:0
  s_nop 1
  v_add_f32_dpp v92, v92, v92 row_shr:2 row_mask:0xf bank_mask:0xf bound_ctrl:0
  s_nop 1
  v_add_f32_dpp v92, v92, v92 row_shr:4 row_mask:0xf bank_mask:0xf bound_ctrl:0
  s_nop 1
  v_add_f32_dpp v92, v92, v92 row_shr:8 row_mask:0xf bank_mask:0xf bound_ctrl:0
  s_nop 1
  v_add_f32_dpp v92, v92, v92 row_bcast:15 row_mask:0xa bank_mask:0xf
  s_nop 1
  v_add_f32_dpp v92, v92, v92 row_bcast:31 row_mask:0xc bank_mask:0xf
  v_add_f32_dpp v93, v93, v93 row_shr:1 row_mask:0xf bank_mask:0xf bound_ctrl:0
  s_nop 1
  v_add_f32_dpp v93, v93, v93 row_shr:2 row_mask:0xf bank_mask:0xf bound_ctrl:0
  s_nop 1
  v_add_f32_dpp v93, v93, v93 row_shr:4 row_mask:0xf bank_mask:0xf bound_ctrl:0
  s_nop 1
  v_add_f32_dpp v93, v93, v93 row_shr:8 row_mask:0xf bank_mask:0xf bound_ctrl:0
  s_nop 1
  v_add_f32_dpp v93, v93, v93 row_bcast:15 row_mask:0xa bank_mask:0xf
  s_nop 1
  v_add_f32_dpp v93, v93, v93 row_bcast:31 row_mask:0xc bank_mask:0xf
  v_mul_f32 v92, 0x3acccccd, v92
  v_mul_f32 v93, 0x3acccccd, v93
  v_fma_f32 v93, -v92, v92, v93
  v_max_f32 v93, 0, v93
  v_add_f32 v93, 0x3727c5ac, v93
  v_rsq_f32 v94, v93
  v_mov_b32 v93, s35
  v_mov_b32 v95, s35
  v_mov_b32 v2, 0
  s_mov_b32 exec_lo, 0
  s_mov_b32 exec_hi, 0x80000000
  buffer_store_dwordx4 v[92:95], v2, s[4:7], s74 offen sc1
  s_mov_b64 exec, -1
P1_end_3:
  s_waitcnt vmcnt(0)
  s_barrier
  s_cmp_eq_u32 s32, 0
  s_cbranch_scc0 pub_52
  s_lshl_b32 s60, s2, 7
  s_add_u32 s60, s60, 4096
  v_mov_b32 v2, s35
  v_mov_b32 v3, s72
  v_mov_b32 v4, 0
  s_mov_b64 exec, 1
  buffer_store_dwordx2 v[2:3], v4, s[4:7], s60 offen sc1
  s_mov_b64 exec, -1
pub_52:
  s_mov_b32 s76, 0
  v_lshlrev_b32 v216, 4, v1
  v_mov_b32 v217, 0
  s_mul_i32 s48, s2, 3
  s_add_u32 s48, s48, s32
  s_sub_u32 s48, s48, 1
  s_sub_u32 s54, s32, 1
  s_cmp_ge_u32 s54, 3
  s_cbranch_scc1 CV_none_53
  s_cmp_ge_u32 s48, 650
  s_cbranch_scc1 CV_none_53
  s_lshl_b32 s54, s54, 13
  s_add_u32 s54, s54, 139264
  v_lshrrev_b32 v2, 4, v1
  v_and_b32 v3, 15, v1
  v_lshrrev_b32 v4, 2, v3
  v_and_b32 v3, 3, v3
  s_cmp_ge_u32 s48, 280
  s_cbranch_scc1 CV_B_54
  s_mov_b32 s76, 1
  v_lshrrev_b32 v5, 1, v2
  v_lshl_add_u32 v5, v5, 3, v4
  v_lshlrev_b32 v5, 9, v5
  v_and_b32 v6, 1, v2
  v_lshl_add_u32 v5, v6, 5, v5
  v_lshl_add_u32 v5, v3, 3, v5
  v_add_u32 v217, s54, v5
  v_lshrrev_b32 v2, 5, v1
  v_mul_u32_u24 v2, 3456, v2
  v_and_b32 v3, 31, v1
  v_lshl_add_u32 v5, v3, 4, v2
  s_mul_i32 s49, s48, 9363
  s_lshr_b32 s49, s49, 16
  s_mul_i32 s50, s49, 7
  s_sub_u32 s50, s48, s50
  s_mul_i32 s51, s49, 55296
  s_lshl_b32 s52, s50, 9
  s_add_u32 s51, s51, s52
  s_mul_i32 s77, s50, 327680
  s_lshl_b32 s52, s49, 10
  s_add_u32 s77, s77, s52
  s_add_u32 s77, s77, 20701184
  s_mov_b32 s78, 40960
  s_add_u32 m0, s54, 0
  s_nop 0
  buffer_load_dwordx4 v5, s[20:23], s51 offen lds
  s_add_u32 s51, s51, 6912
  s_add_u32 m0, s54, 1024
  s_nop 0
  buffer_load_dwordx4 v5, s[20:23], s51 offen lds
  s_add_u32 s51, s51, 6912
  s_add_u32 m0, s54, 2048
  s_nop 0
  buffer_load_dwordx4 v5, s[20:23], s51 offen lds
  s_add_u32 s51, s51, 6912
  s_add_u32 m0, s54, 3072
  s_nop 0
  buffer_load_dwordx4 v5, s[20:23], s51 offen lds
  s_add_u32 s51, s51, 6912
  s_add_u32 m0, s54, 4096
  s_nop 0
  buffer_load_dwordx4 v5, s[20:23], s51 offen lds
  s_add_u32 s51, s51, 6912
  s_add_u32 m0, s54, 5120
  s_nop 0
  buffer_load_dwordx4 v5, s[20:23], s51 offen lds
  s_add_u32 s51, s51, 6912
  s_add_u32 m0, s54, 6144
  s_nop 0
  buffer_load_dwordx4 v5, s[20:23], s51 offen lds
  s_add_u32 s51, s51, 6912
  s_add_u32 m0, s54, 7168
  s_nop 0
  buffer_load_dwordx4 v5, s[20:23], s51 offen lds
  s_add_u32 s51, s51, 6912
  s_branch CV_none_53
CV_B_54:
  s_mov_b32 s76, 2
  v_lshl_add_u32 v5, v2, 3, v4
  v_lshlrev_b32 v5, 8, v5
  v_lshl_add_u32 v5, v3, 3, v5
  v_add_u32 v217, s54, v5
  v_lshrrev_b32 v2, 4, v1
  v_mul_u32_u24 v2, 1280, v2
  v_and_b32 v3, 15, v1
  v_lshl_add_u32 v5, v3, 4, v2
  s_cmp_lt_u32 s48, 380
  s_mov_b32 s53, 380
  s_cselect_b32 s53, 280, s53
  s_cselect_b32 s56, s16, s24
  s_cselect_b32 s57, s17, s25
  s_cselect_b32 s58, s18, s26
  s_mov_b32 s59, 0x20000
  s_mov_b32 s77, 23814144
  s_cselect_b32 s77, 22994944, s77
  s_cselect_b32 s78, 20, 54
  s_sub_u32 s53, s48, s53
  s_lshl_b32 s78, s78, 10
  s_mul_i32 s49, s53, 13108
  s_lshr_b32 s49, s49, 16
  s_mul_i32 s50, s49, 5
  s_sub_u32 s50, s53, s50
  s_mul_i32 s51, s49, 40960
  s_lshl_b32 s52, s50, 8
  s_add_u32 s51, s51, s52
  s_lshl_b32 s52, s50, 3
  s_mul_i32 s52, s52, s78
  s_add_u32 s77, s77, s52
  s_lshl_b32 s49, s49, 10
  s_add_u32 s77, s77, s49
  s_add_u32 m0, s54, 0
  s_nop 0
  buffer_load_dwordx4 v5, s[56:59], s51 offen lds
  s_add_u32 s51, s51, 5120
  s_add_u32 m0, s54, 1024
  s_nop 0
  buffer_load_dwordx4 v5, s[56:59], s51 offen lds
  s_add_u32 s51, s51, 5120
  s_add_u32 m0, s54, 2048
  s_nop 0
  buffer_load_dwordx4 v5, s[56:59], s51 offen lds
  s_add_u32 s51, s51, 5120
  s_add_u32 m0, s54, 3072
  s_nop 0
  buffer_load_dwordx4 v5, s[56:59], s51 offen lds
  s_add_u32 s51, s51, 5120
  s_add_u32 m0, s54, 4096
  s_nop 0
  buffer_load_dwordx4 v5, s[56:59], s51 offen lds
  s_add_u32 s51, s51, 5120
  s_add_u32 m0, s54, 5120
  s_nop 0
  buffer_load_dwordx4 v5, s[56:59], s51 offen lds
  s_add_u32 s51, s51, 5120
  s_add_u32 m0, s54, 6144
  s_nop 0
  buffer_load_dwordx4 v5, s[56:59], s51 offen lds
  s_add_u32 s51, s51, 5120
  s_add_u32 m0, s54, 7168
  s_nop 0
  buffer_load_dwordx4 v5, s[56:59], s51 offen lds
  s_add_u32 s51, s51, 5120
CV_none_53:
  s_lshr_b32 s43, s34, 3
  s_lshl_b32 s36, s33, 2
  s_add_u32 s36, s36, s43
  s_and_b32 s37, s34, 7
  s_and_b32 s51, s32, 3
  s_lshr_b32 s42, s32, 2
  v_lshlrev_b32 v128, 4, v1
  s_lshl_b32 s43, s36, 6
  s_lshl_b32 s44, s42, 5
  s_add_u32 s44, s44, s51
  s_add_u32 s44, s44, s43
  s_mul_i32 s38, s44, 2560
  s_add_u32 s38, s38, 2756608
  s_mul_i32 s39, s32, 3072
  s_mul_i32 s66, s37, 7
  s_cmp_eq_u32 s37, 7
  s_cselect_b32 s66, 48, s66
  s_cmp_lt_u32 s37, 6
  s_cselect_b32 s67, 7, 6
  s_add_u32 s66, s66, s32
  s_mul_i32 s64, s66, 40960
  s_add_u32 s64, s64, 20710400
  s_mul_i32 s65, s37, 102400
  s_add_u32 s65, s65, 22994944
  s_mul_i32 s69, s32, 7
  s_cmp_eq_u32 s32, 7
  s_cselect_b32 s69, 48, s69
  s_cmp_lt_u32 s32, 6
  s_cselect_b32 s70, 7, 6
  s_mul_i32 s73, s36, 81920
  s_mul_i32 s54, s37, 10240
  s_add_u32 s73, s73, s54
  s_add_u32 s73, s73, 8118272
  s_mul_i32 s74, s36, 40
  s_mul_i32 s54, s37, 5
  s_add_u32 s74, s74, s54
  s_lshl_b32 s74, s74, 11
  s_add_u32 s74, s74, 10729472
  s_lshl_b32 s75, s36, 4
  s_lshl_b32 s54, s37, 1
  s_add_u32 s75, s75, s54
  s_lshl_b32 s75, s75, 9
  s_add_u32 s75, s75, 13361152
  s_mul_i32 s82, s36, 54
  s_add_u32 s82, s82, s66
  s_sub_u32 s82, s82, s32
  s_lshl_b32 s82, s82, 12
  s_add_u32 s82, s82, 13623296
  s_lshl_b32 s83, s67, 2
  s_sub_u32 s83, s83, 1
  v_mov_b32 v224, -1
  v_mov_b32 v225, -1
  v_mov_b32 v226, -1
  v_mov_b32 v227, -1
  v_lshlrev_b32 v228, 7, v1
  s_mul_i32 s54, s32, 7
  s_add_u32 s54, s54, 0
  s_lshl_b32 s55, s54, 10
  s_add_u32 s56, s55, s73
  s_add_u32 s57, s55, s74
  s_cmp_lt_u32 s54, 10
  s_cselect_b32 s56, s56, s57
  s_cmp_eq_u32 s54, 20
  s_cselect_b32 s56, s75, s56
  s_sub_u32 s57, s54, 21
  s_min_u32 s57, s57, s83
  s_lshl_b32 s57, s57, 10
  s_add_u32 s57, s57, s82
  s_cmp_ge_u32 s54, 21
  s_cselect_b32 s96, s57, s56
  s_mul_i32 s54, s32, 7
  s_add_u32 s54, s54, 1
  s_lshl_b32 s55, s54, 10
  s_add_u32 s56, s55, s73
  s_add_u32 s57, s55, s74
  s_cmp_lt_u32 s54, 10
  s_cselect_b32 s56, s56, s57
  s_cmp_eq_u32 s54, 20
  s_cselect_b32 s56, s75, s56
  s_sub_u32 s57, s54, 21
  s_min_u32 s57, s57, s83
  s_lshl_b32 s57, s57, 10
  s_add_u32 s57, s57, s82
  s_cmp_ge_u32 s54, 21
  s_cselect_b32 s97, s57, s56
  s_mul_i32 s54, s32, 7
  s_add_u32 s54, s54, 2
  s_lshl_b32 s55, s54, 10
  s_add_u32 s56, s55, s73
  s_add_u32 s57, s55, s74
  s_cmp_lt_u32 s54, 10
  s_cselect_b32 s56, s56, s57
  s_cmp_eq_u32 s54, 20
  s_cselect_b32 s56, s75, s56
  s_sub_u32 s57, s54, 21
  s_min_u32 s57, s57, s83
  s_lshl_b32 s57, s57, 10
  s_add_u32 s57, s57, s82
  s_cmp_ge_u32 s54, 21
  s_cselect_b32 s98, s57, s56
  s_mul_i32 s54, s32, 7
  s_add_u32 s54, s54, 3
  s_lshl_b32 s55, s54, 10
  s_add_u32 s56, s55, s73
  s_add_u32 s57, s55, s74
  s_cmp_lt_u32 s54, 10
  s_cselect_b32 s56, s56, s57
  s_cmp_eq_u32 s54, 20
  s_cselect_b32 s56, s75, s56
  s_sub_u32 s57, s54, 21
  s_min_u32 s57, s57, s83
  s_lshl_b32 s57, s57, 10
  s_add_u32 s57, s57, s82
  s_cmp_ge_u32 s54, 21
  s_cselect_b32 s99, s57, s56
  s_mul_i32 s54, s32, 7
  s_add_u32 s54, s54, 4
  s_lshl_b32 s55, s54, 10
  s_add_u32 s56, s55, s73
  s_add_u32 s57, s55, s74
  s_cmp_lt_u32 s54, 10
  s_cselect_b32 s56, s56, s57
  s_cmp_eq_u32 s54, 20
  s_cselect_b32 s56, s75, s56
  s_sub_u32 s57, s54, 21
  s_min_u32 s57, s57, s83
  s_lshl_b32 s57, s57, 10
  s_add_u32 s57, s57, s82
  s_cmp_ge_u32 s54, 21
  s_cselect_b32 s100, s57, s56
  s_mul_i32 s54, s32, 7
  s_add_u32 s54, s54, 5
  s_lshl_b32 s55, s54, 10
  s_add_u32 s56, s55, s73
  s_add_u32 s57, s55, s74
  s_cmp_lt_u32 s54, 10
  s_cselect_b32 s56, s56, s57
  s_cmp_eq_u32 s54, 20
  s_cselect_b32 s56, s75, s56
  s_sub_u32 s57, s54, 21
  s_min_u32 s57, s57, s83
  s_lshl_b32 s57, s57, 10
  s_add_u32 s57, s57, s82
  s_cmp_ge_u32 s54, 21
  s_cselect_b32 s101, s57, s56
  s_mul_i32 s54, s32, 7
  s_add_u32 s54, s54, 6
  s_lshl_b32 s55, s54, 10
  s_add_u32 s56, s55, s73
  s_add_u32 s57, s55, s74
  s_cmp_lt_u32 s54, 10
  s_cselect_b32 s56, s56, s57
  s_cmp_eq_u32 s54, 20
  s_cselect_b32 s56, s75, s56
  s_sub_u32 s57, s54, 21
  s_min_u32 s57, s57, s83
  s_lshl_b32 s57, s57, 10
  s_add_u32 s57, s57, s82
  s_cmp_ge_u32 s54, 21
  s_cselect_b32 s71, s57, s56
  s_cmp_eq_u32 s32, 0
  s_cbranch_scc0 wf_skip_55
  v_and_b32 v248, 15, v1
  v_bfe_u32 v249, v1, 4, 1
  v_mul_u32_u24 v249, 19, v249
  s_mul_i32 s59, s36, 20
  v_add_u32 v249, s59, v249
  v_lshrrev_b32 v249, 7, v249
  v_add_u32 v249, 5, v249
  v_lshrrev_b32 v240, 2, v248
  v_lshrrev_b32 v246, 3, v249
  v_lshl_add_u32 v240, v246, 2, v240
  v_and_b32 v246, 7, v249
  v_lshlrev_b32 v246, 2, v246
  v_and_b32 v247, 3, v248
  v_or_b32 v246, v246, v247
  v_lshl_add_u32 v240, v246, 3, v240
  v_lshlrev_b32 v240, 7, v240
  v_and_b32 v248, 15, v1
  v_bfe_u32 v249, v1, 4, 1
  v_mul_u32_u24 v249, 19, v249
  s_mul_i32 s59, s36, 20
  v_add_u32 v249, s59, v249
  v_lshrrev_b32 v249, 7, v249
  v_add_u32 v249, 10, v249
  v_lshrrev_b32 v242, 2, v248
  v_lshrrev_b32 v246, 3, v249
  v_lshl_add_u32 v242, v246, 2, v242
  v_and_b32 v246, 7, v249
  v_lshlrev_b32 v246, 2, v246
  v_and_b32 v247, 3, v248
  v_or_b32 v246, v246, v247
  v_lshl_add_u32 v242, v246, 3, v242
  v_lshlrev_b32 v242, 7, v242
  v_and_b32 v248, 1, v1
  s_lshl_b32 s59, s37, 1
  v_add_u32 v248, s59, v248
  v_bfe_u32 v249, v1, 1, 1
  v_mul_u32_u24 v249, 19, v249
  s_mul_i32 s59, s36, 20
  v_add_u32 v249, s59, v249
  v_lshrrev_b32 v249, 7, v249
  v_lshrrev_b32 v244, 2, v248
  v_lshrrev_b32 v246, 3, v249
  v_lshl_add_u32 v244, v246, 2, v244
  v_and_b32 v246, 7, v249
  v_lshlrev_b32 v246, 2, v246
  v_and_b32 v247, 3, v248
  v_or_b32 v246, v246, v247
  v_lshl_add_u32 v244, v246, 3, v244
  v_lshlrev_b32 v244, 7, v244
  s_mov_b32 s60, 4096
  s_mov_b32 s61, 0
wf_poll_56:
  buffer_load_dword v241, v240, s[4:7], s60 offen sc1
  buffer_load_dword v243, v242, s[4:7], s60 offen sc1
  buffer_load_dword v245, v244, s[4:7], s60 offen sc1
  s_waitcnt vmcnt(0)
  s_mov_b64 s[62:63], 0
  v_cmp_ne_u32 vcc, s35, v241
  s_and_b32 vcc_lo, vcc_lo, 0xffffffff
  s_and_b32 vcc_hi, vcc_hi, 0x0
  s_or_b64 s[62:63], s[62:63], vcc
  v_cmp_ne_u32 vcc, s35, v243
  s_and_b32 vcc_lo, vcc_lo, 0xffffffff
  s_and_b32 vcc_hi, vcc_hi, 0x0
  s_or_b64 s[62:63], s[62:63], vcc
  v_cmp_ne_u32 vcc, s35, v245
  s_and_b32 vcc_lo, vcc_lo, 0xf
  s_and_b32 vcc_hi, vcc_hi, 0x0
  s_or_b64 s[62:63], s[62:63], vcc
  s_cmp_eq_u64 s[62:63], 0
  s_cbranch_scc1 wf_done_57
  s_add_u32 s61, s61, 1
  s_cmp_lt_u32 s61, 1048576
  s_cbranch_scc1 wf_poll_56
wf_done_57:
wf_skip_55:
  s_barrier
  s_lshl_b32 s47, s37, 3
  s_lshl_b32 s44, s51, 1
  s_add_u32 s47, s47, s44
  s_add_u32 s44, s47, s43
  s_add_u32 s47, s47, s42
  s_add_u32 s45, s44, s42
  s_mul_i32 s45, s45, 1280
  s_add_u32 s45, s45, 135168
  s_xor_b32 s48, s42, 1
  s_add_u32 s44, s44, s48
  s_mul_i32 s44, s44, 1280
  s_add_u32 s44, s44, 135168
  v_mov_b32 v16, 0
  v_mov_b32 v17, 0
  v_mov_b32 v18, 0
  v_mov_b32 v19, 0
  v_lshlrev_b32 v2, 3, v1
  v_lshlrev_b32 v3, 7, v1
  s_mul_i32 s48, s36, 20
  s_lshr_b32 s49, s48, 6
  s_add_u32 s48, s48, 19
  s_lshr_b32 s48, s48, 6
  s_lshl_b32 s48, s48, 13
  s_lshl_b32 s49, s49, 13
  s_add_u32 s48, s48, 8003584
  s_add_u32 s49, s49, 8003584
  buffer_load_dwordx4 v[12:15], v128, s[4:7], s45 offen sc1
  buffer_load_dwordx4 v[60:63], v128, s[4:7], s44 offen sc1
  buffer_load_dword v129, v3, s[4:7], s48 offen sc1
  buffer_load_dword v4, v3, s[4:7], s49 offen sc1
  s_mov_b64 exec, 0xffffffff
  buffer_load_dwordx2 v[16:17], v2, s[4:7], s45 offen offset:1024 sc1
  buffer_load_dwordx2 v[18:19], v2, s[4:7], s44 offen offset:1024 sc1
  s_mov_b64 exec, -1
  s_add_u32 m0, s39, 0
  s_nop 0
  buffer_load_dwordx4 v128, s[4:7], s38 offen sc1 lds
  buffer_load_dwordx4 v128, s[4:7], s38 offen offset:1024 sc1 lds
  s_mov_b64 exec, 0xffffffff
  buffer_load_dwordx4 v128, s[4:7], s38 offen offset:2048 sc1 lds
  s_mov_b64 exec, -1
  s_add_u32 s38, s38, 10240
  s_add_u32 m0, s39, 24576
  s_nop 0
  buffer_load_dwordx4 v128, s[4:7], s38 offen sc1 lds
  buffer_load_dwordx4 v128, s[4:7], s38 offen offset:1024 sc1 lds
  s_mov_b64 exec, 0xffffffff
  buffer_load_dwordx4 v128, s[4:7], s38 offen offset:2048 sc1 lds
  s_mov_b64 exec, -1
  s_add_u32 s38, s38, 10240
  s_waitcnt vmcnt(8)
  v_max_f32 v129, v129, v4
  v_mul_f32 v129, 0x40a00000, v129
  v_and_b32 v8, 31, v1
  v_lshrrev_b32 v9, 5, v1
  v_cmp_eq_u32 vcc, 1, v9
  v_lshlrev_b32 v2, 3, v8
  v_add_u32 v2, 1024, v2
  v_mov_b32 v3, 2560
  v_cndmask_b32 v21, v2, v3, vcc
  v_mul_u32_u24 v2, 320, v9
  v_lshl_add_u32 v2, v8, 4, v2
  v_add_u32 v2, 1280, v2
  v_add_u32 v3, 640, v2
  v_mov_b32 v4, 2592
  v_mov_b32 v5, 2576
  v_cmp_eq_u32 vcc, 20, v8
  s_mul_i32 s46, s42, 12288
  s_nop 0
  v_cndmask_b32 v4, v4, v5, vcc
  v_cmp_gt_u32 vcc, 20, v8
  v_add_u32 v20, s46, v128
  v_add_u32 v21, s46, v21
  v_cndmask_b32 v22, v4, v2, vcc
  v_cndmask_b32 v23, v4, v3, vcc
  v_add_u32 v22, s46, v22
  v_add_u32 v23, s46, v23
  s_lshl_b32 s43, s47, 5
  s_lshr_b32 s44, s43, 6
  s_mul_i32 s44, s44, 81920
  s_lshr_b32 s45, s43, 4
  s_and_b32 s45, s45, 3
  s_lshl_b32 s45, s45, 10
  s_add_u32 s44, s44, s45
  s_add_u32 s46, s44, 8118272
  v_lshrrev_b32 v3, 4, v8
  v_lshlrev_b32 v3, 10, v3
  v_and_b32 v4, 15, v8
  v_lshl_add_u32 v3, v4, 4, v3
  s_mul_i32 s43, s36, 20
  s_and_b32 s45, s36, 1
  s_lshl_b32 s48, s45, 2
  s_add_u32 s48, s48, s43
  v_lshlrev_b32 v4, 3, v9
  v_add_u32 v4, s48, v4
  v_lshrrev_b32 v5, 5, v4
  v_lshl_add_u32 v130, v5, 12, v3
  v_bfe_u32 v5, v4, 3, 2
  v_lshl_add_u32 v130, v5, 8, v130
  v_bfe_u32 v5, v4, 2, 1
  v_lshl_add_u32 v130, v5, 3, v130
  s_cmp_eq_u32 s45, 0
  s_cselect_b32 s48, 16, 0
  s_add_u32 s48, s48, s43
  v_mov_b32 v4, s48
  v_lshrrev_b32 v5, 5, v4
  v_lshl_add_u32 v131, v5, 12, v3
  v_bfe_u32 v5, v4, 3, 2
  v_lshl_add_u32 v131, v5, 8, v131
  v_bfe_u32 v5, v4, 2, 1
  v_lshl_add_u32 v131, v5, 3, v131
  s_cmp_eq_u32 s32, 0
  s_cbranch_scc0 P2_const_58
  v_lshrrev_b32 v2, 3, v1
  v_mul_u32_u24 v2, 24576, v2
  v_and_b32 v24, 7, v1
  v_mul_u32_u24 v24, 3072, v24
  v_add_u32 v24, v24, v2
  v_mov_b32 v28, 0x3f803f80
  v_mov_b32 v29, 0x3f803f80
  v_mov_b32 v30, 0x3f803f80
  v_mov_b32 v31, 0x3f803f80
  v_mov_b32 v32, 0
  v_mov_b32 v33, 0
  v_mov_b32 v34, 0
  v_mov_b32 v35, 0
  v_mov_b32 v26, 0x3f803f80
  v_mov_b32 v27, 0x00003f80
  s_mov_b64 exec, 0xffffff
  ds_write_b64 v24, v[26:27] offset:2560
  ds_write_b128 v24, v[28:31] offset:2576
  ds_write_b128 v24, v[32:35] offset:2592
  s_mov_b64 exec, -1
  s_waitcnt lgkmcnt(0)
P2_const_58:
  v_mov_b32 v96, 0
  v_mov_b32 v97, 0
  v_mov_b32 v98, 0
  v_mov_b32 v99, 0
  v_mov_b32 v100, 0
  v_mov_b32 v101, 0
  v_mov_b32 v102, 0
  v_mov_b32 v103, 0
  v_mov_b32 v104, 0
  v_mov_b32 v105, 0
  v_mov_b32 v106, 0
  v_mov_b32 v107, 0
  v_mov_b32 v108, 0
  v_mov_b32 v109, 0
  v_mov_b32 v110, 0
  v_mov_b32 v111, 0
  v_mov_b32 v112, 0
  v_mov_b32 v113, 0
  v_mov_b32 v114, 0
  v_mov_b32 v115, 0
  v_mov_b32 v116, 0
  v_mov_b32 v117, 0
  v_mov_b32 v118, 0
  v_mov_b32 v119, 0
  v_mov_b32 v120, 0
  v_mov_b32 v121, 0
  v_mov_b32 v122, 0
  v_mov_b32 v123, 0
  v_mov_b32 v124, 0
  v_mov_b32 v125, 0
  v_mov_b32 v126, 0
  v_mov_b32 v127, 0
  v_mov_b32 v56, 0
  v_mov_b32 v57, 0
  v_mov_b32 v58, 0
  v_mov_b32 v59, 0
  v_mov_b32 v48, 0
  v_mov_b32 v49, 0
  v_mov_b32 v50, 0
  v_mov_b32 v51, 0
  s_waitcnt vmcnt(6)
  v_max_f32_dpp v129, v129, v129 row_shr:1 row_mask:0xf bank_mask:0xf
  s_nop 1
  v_max_f32_dpp v129, v129, v129 row_shr:2 row_mask:0xf bank_mask:0xf
  s_nop 1
  v_max_f32_dpp v129, v129, v129 row_shr:4 row_mask:0xf bank_mask:0xf
  s_nop 1
  v_max_f32_dpp v129, v129, v129 row_shr:8 row_mask:0xf bank_mask:0xf
  s_nop 1
  v_max_f32_dpp v129, v129, v129 row_bcast:15 row_mask:0xa bank_mask:0xf
  s_nop 1
  v_max_f32_dpp v129, v129, v129 row_bcast:31 row_mask:0xc bank_mask:0xf
  s_nop 0
  v_readlane_b32 s43, v129, 63
  v_mov_b32 v10, 0
  v_dot2c_f32_bf16 v10, v12, v12
  v_dot2c_f32_bf16 v10, v13, v13
  v_dot2c_f32_bf16 v10, v14, v14
  v_dot2c_f32_bf16 v10, v15, v15
  v_dot2c_f32_bf16 v10, v16, v16
  v_dot2c_f32_bf16 v10, v17, v17
  s_nop 2
  v_mov_b32 v2, v10
  s_nop 1
  v_permlane32_swap_b32 v10, v2
  v_add_f32 v10, v10, v2
  v_mul_f32 v10, s43, v10
  v_sqrt_f32 v10, v10
  s_nop 0
  v_mul_f32 v10, 0xbf802000, v10
  v_and_b32 v2, 0xffff0000, v10
  v_sub_f32 v3, v10, v2
  v_and_b32 v4, 0xffff0000, v3
  v_sub_f32 v3, v3, v4
  v_lshrrev_b32 v2, 16, v2
  v_or_b32 v2, v2, v4
  v_lshrrev_b32 v3, 16, v3
  v_cmp_eq_u32 vcc, 1, v9
  s_nop 1
  v_cndmask_b32 v16, v16, v2, vcc
  v_cndmask_b32 v17, v17, v3, vcc
  v_mov_b32 v10, 0
  v_dot2c_f32_bf16 v10, v60, v60
  v_dot2c_f32_bf16 v10, v61, v61
  v_dot2c_f32_bf16 v10, v62, v62
  v_dot2c_f32_bf16 v10, v63, v63
  v_dot2c_f32_bf16 v10, v18, v18
  v_dot2c_f32_bf16 v10, v19, v19
  s_nop 2
  v_mov_b32 v2, v10
  s_nop 1
  v_permlane32_swap_b32 v10, v2
  v_add_f32 v10, v10, v2
  v_mul_f32 v10, s43, v10
  v_sqrt_f32 v10, v10
  s_nop 0
  v_mul_f32 v10, 0xbf802000, v10
  v_and_b32 v2, 0xffff0000, v10
  v_sub_f32 v3, v10, v2
  v_and_b32 v4, 0xffff0000, v3
  v_sub_f32 v3, v3, v4
  v_lshrrev_b32 v2, 16, v2
  v_or_b32 v2, v2, v4
  v_lshrrev_b32 v3, 16, v3
  v_cmp_eq_u32 vcc, 1, v9
  s_nop 1
  v_cndmask_b32 v18, v18, v2, vcc
  v_cndmask_b32 v19, v19, v3, vcc
  s_waitcnt vmcnt(3)
  s_barrier
  ds_read_b128 v[24:27], v20 offset:0
  ds_read_b64 v[32:33], v21 offset:0
  ds_read_b128 v[36:39], v22 offset:0
  ds_read_b128 v[44:47], v23 offset:0
  s_waitcnt lgkmcnt(2)
  v_mfma_f32_32x32x16_bf16 v[64:79], v[24:27], v[12:15], 0
  v_mfma_f32_32x32x8_bf16 v[64:79], v[32:33], v[16:17], v[64:79]
  s_setprio 1
  v_mfma_f32_32x32x16_bf16 v[80:95], v[24:27], v[60:63], 0
  s_nop 9
  v_exp_f32 v64, v64
  v_exp_f32 v65, v65
  v_exp_f32 v66, v66
  v_exp_f32 v67, v67
  v_mfma_f32_32x32x16_bf16 v[112:127], v[48:51], v[56:59], v[112:127]
  ds_read_b128 v[28:31], v20 offset:3072
  ds_read_b64 v[34:35], v21 offset:3072
  v_exp_f32 v68, v68
  v_exp_f32 v69, v69
  v_exp_f32 v70, v70
  v_exp_f32 v71, v71
  v_cvt_pk_bf16_f32 v52, v64, v65
  v_cvt_pk_bf16_f32 v53, v66, v67
  v_mfma_f32_32x32x8_bf16 v[80:95], v[32:33], v[18:19], v[80:95]
  v_cvt_pk_bf16_f32 v54, v68, v69
  v_cvt_pk_bf16_f32 v55, v70, v71
  v_exp_f32 v72, v72
  v_exp_f32 v73, v73
  v_exp_f32 v74, v74
  v_exp_f32 v75, v75
  s_waitcnt lgkmcnt(2)
  buffer_store_dwordx4 v[224:227], v128, s[4:7], s96 offen sc1
  v_mfma_f32_32x32x16_bf16 v[96:111], v[36:39], v[52:55], v[96:111]
  v_exp_f32 v76, v76
  v_exp_f32 v77, v77
  v_exp_f32 v78, v78
  v_exp_f32 v79, v79
  v_cvt_pk_bf16_f32 v56, v72, v73
  v_cvt_pk_bf16_f32 v57, v74, v75
  v_cvt_pk_bf16_f32 v58, v76, v77
  v_cvt_pk_bf16_f32 v59, v78, v79
  s_setprio 0
  s_waitcnt lgkmcnt(0)
  v_mfma_f32_32x32x16_bf16 v[64:79], v[28:31], v[12:15], 0
  v_exp_f32 v80, v80
  v_exp_f32 v81, v81
  v_exp_f32 v82, v82
  v_exp_f32 v83, v83
  v_mfma_f32_32x32x16_bf16 v[96:111], v[44:47], v[56:59], v[96:111]
  ds_read_b128 v[40:43], v22 offset:3072
  ds_read_b128 v[48:51], v23 offset:3072
  v_exp_f32 v84, v84
  v_exp_f32 v85, v85
  v_exp_f32 v86, v86
  v_exp_f32 v87, v87
  v_cvt_pk_bf16_f32 v52, v80, v81
  v_cvt_pk_bf16_f32 v53, v82, v83
  v_mfma_f32_32x32x8_bf16 v[64:79], v[34:35], v[16:17], v[64:79]
  v_cvt_pk_bf16_f32 v54, v84, v85
  v_cvt_pk_bf16_f32 v55, v86, v87
  v_exp_f32 v88, v88
  v_exp_f32 v89, v89
  v_exp_f32 v90, v90
  v_exp_f32 v91, v91
  buffer_store_dwordx4 v[224:227], v128, s[4:7], s97 offen sc1
  v_mfma_f32_32x32x16_bf16 v[112:127], v[36:39], v[52:55], v[112:127]
  v_exp_f32 v92, v92
  v_exp_f32 v93, v93
  v_exp_f32 v94, v94
  v_exp_f32 v95, v95
  v_cvt_pk_bf16_f32 v56, v88, v89
  v_cvt_pk_bf16_f32 v57, v90, v91
  v_cvt_pk_bf16_f32 v58, v92, v93
  v_cvt_pk_bf16_f32 v59, v94, v95
  s_setprio 1
  v_mfma_f32_32x32x16_bf16 v[80:95], v[28:31], v[60:63], 0
  v_exp_f32 v64, v64
  v_exp_f32 v65, v65
  v_exp_f32 v66, v66
  v_exp_f32 v67, v67
  v_mfma_f32_32x32x16_bf16 v[112:127], v[44:47], v[56:59], v[112:127]
  ds_read_b128 v[24:27], v20 offset:6144
  ds_read_b64 v[32:33], v21 offset:6144
  v_exp_f32 v68, v68
  v_exp_f32 v69, v69
  v_exp_f32 v70, v70
  v_exp_f32 v71, v71
  v_cvt_pk_bf16_f32 v52, v64, v65
  v_cvt_pk_bf16_f32 v53, v66, v67
  v_mfma_f32_32x32x8_bf16 v[80:95], v[34:35], v[18:19], v[80:95]
  v_cvt_pk_bf16_f32 v54, v68, v69
  v_cvt_pk_bf16_f32 v55, v70, v71
  v_exp_f32 v72, v72
  v_exp_f32 v73, v73
  v_exp_f32 v74, v74
  v_exp_f32 v75, v75
  s_waitcnt lgkmcnt(2)
  buffer_store_dwordx4 v[224:227], v128, s[4:7], s98 offen sc1
  v_mfma_f32_32x32x16_bf16 v[96:111], v[40:43], v[52:55], v[96:111]
  v_exp_f32 v76, v76
  v_exp_f32 v77, v77
  v_exp_f32 v78, v78
  v_exp_f32 v79, v79
  v_cvt_pk_bf16_f32 v56, v72, v73
  v_cvt_pk_bf16_f32 v57, v74, v75
  v_cvt_pk_bf16_f32 v58, v76, v77
  v_cvt_pk_bf16_f32 v59, v78, v79
  s_setprio 0
  s_waitcnt lgkmcnt(0)
  v_mfma_f32_32x32x16_bf16 v[64:79], v[24:27], v[12:15], 0
  v_exp_f32 v80, v80
  v_exp_f32 v81, v81
  v_exp_f32 v82, v82
  v_exp_f32 v83, v83
  v_mfma_f32_32x32x16_bf16 v[96:111], v[48:51], v[56:59], v[96:111]
  ds_read_b128 v[36:39], v22 offset:6144
  ds_read_b128 v[44:47], v23 offset:6144
  v_exp_f32 v84, v84
  v_exp_f32 v85, v85
  v_exp_f32 v86, v86
  v_exp_f32 v87, v87
  v_cvt_pk_bf16_f32 v52, v80, v81
  v_cvt_pk_bf16_f32 v53, v82, v83
  v_mfma_f32_32x32x8_bf16 v[64:79], v[32:33], v[16:17], v[64:79]
  v_cvt_pk_bf16_f32 v54, v84, v85
  v_cvt_pk_bf16_f32 v55, v86, v87
  v_exp_f32 v88, v88
  v_exp_f32 v89, v89
  v_exp_f32 v90, v90
  v_exp_f32 v91, v91
  buffer_store_dwordx4 v[224:227], v128, s[4:7], s99 offen sc1
  v_mfma_f32_32x32x16_bf16 v[112:127], v[40:43], v[52:55], v[112:127]
  v_exp_f32 v92, v92
  v_exp_f32 v93, v93
  v_exp_f32 v94, v94
  v_exp_f32 v95, v95
  v_cvt_pk_bf16_f32 v56, v88, v89
  v_cvt_pk_bf16_f32 v57, v90, v91
  v_cvt_pk_bf16_f32 v58, v92, v93
  v_cvt_pk_bf16_f32 v59, v94, v95
  s_setprio 1
  v_mfma_f32_32x32x16_bf16 v[80:95], v[24:27], v[60:63], 0
  v_exp_f32 v64, v64
  v_exp_f32 v65, v65
  v_exp_f32 v66, v66
  v_exp_f32 v67, v67
  v_mfma_f32_32x32x16_bf16 v[112:127], v[48:51], v[56:59], v[112:127]
  ds_read_b128 v[28:31], v20 offset:9216
  ds_read_b64 v[34:35], v21 offset:9216
  v_exp_f32 v68, v68
  v_exp_f32 v69, v69
  v_exp_f32 v70, v70
  v_exp_f32 v71, v71
  v_cvt_pk_bf16_f32 v52, v64, v65
  v_cvt_pk_bf16_f32 v53, v66, v67
  v_mfma_f32_32x32x8_bf16 v[80:95], v[32:33], v[18:19], v[80:95]
  v_cvt_pk_bf16_f32 v54, v68, v69
  v_cvt_pk_bf16_f32 v55, v70, v71
  v_exp_f32 v72, v72
  v_exp_f32 v73, v73
  v_exp_f32 v74, v74
  v_exp_f32 v75, v75
  s_waitcnt lgkmcnt(2)
  buffer_store_dwordx4 v[224:227], v128, s[4:7], s100 offen sc1
  v_mfma_f32_32x32x16_bf16 v[96:111], v[36:39], v[52:55], v[96:111]
  v_exp_f32 v76, v76
  v_exp_f32 v77, v77
  v_exp_f32 v78, v78
  v_exp_f32 v79, v79
  v_cvt_pk_bf16_f32 v56, v72, v73
  v_cvt_pk_bf16_f32 v57, v74, v75
  v_cvt_pk_bf16_f32 v58, v76, v77
  v_cvt_pk_bf16_f32 v59, v78, v79
  s_setprio 0
  s_waitcnt lgkmcnt(0)
  v_mfma_f32_32x32x16_bf16 v[64:79], v[28:31], v[12:15], 0
  v_exp_f32 v80, v80
  v_exp_f32 v81, v81
  v_exp_f32 v82, v82
  v_exp_f32 v83, v83
  v_mfma_f32_32x32x16_bf16 v[96:111], v[44:47], v[56:59], v[96:111]
  ds_read_b128 v[40:43], v22 offset:9216
  ds_read_b128 v[48:51], v23 offset:9216
  v_exp_f32 v84, v84
  v_exp_f32 v85, v85
  v_exp_f32 v86, v86
  v_exp_f32 v87, v87
  v_cvt_pk_bf16_f32 v52, v80, v81
  v_cvt_pk_bf16_f32 v53, v82, v83
  v_mfma_f32_32x32x8_bf16 v[64:79], v[34:35], v[16:17], v[64:79]
  v_cvt_pk_bf16_f32 v54, v84, v85
  v_cvt_pk_bf16_f32 v55, v86, v87
  v_exp_f32 v88, v88
  v_exp_f32 v89, v89
  v_exp_f32 v90, v90
  v_exp_f32 v91, v91
  buffer_store_dwordx4 v[224:227], v128, s[4:7], s101 offen sc1
  v_mfma_f32_32x32x16_bf16 v[112:127], v[36:39], v[52:55], v[112:127]
  v_exp_f32 v92, v92
  v_exp_f32 v93, v93
  v_exp_f32 v94, v94
  v_exp_f32 v95, v95
  v_cvt_pk_bf16_f32 v56, v88, v89
  v_cvt_pk_bf16_f32 v57, v90, v91
  v_cvt_pk_bf16_f32 v58, v92, v93
  v_cvt_pk_bf16_f32 v59, v94, v95
  s_waitcnt vmcnt(6)
  s_barrier
  s_setprio 1
  v_mfma_f32_32x32x16_bf16 v[80:95], v[28:31], v[60:63], 0
  v_exp_f32 v64, v64
  v_exp_f32 v65, v65
  v_exp_f32 v66, v66
  v_exp_f32 v67, v67
  v_mfma_f32_32x32x16_bf16 v[112:127], v[44:47], v[56:59], v[112:127]
  ds_read_b128 v[24:27], v20 offset:24576
  ds_read_b64 v[32:33], v21 offset:24576
  s_cmp_eq_u32 s42, 0
  s_cbranch_scc0 P2_nodma_59
  s_add_u32 m0, s39, 49152
  s_nop 0
  buffer_load_dwordx4 v128, s[4:7], s38 offen sc1 lds
  buffer_load_dwordx4 v128, s[4:7], s38 offen offset:1024 sc1 lds
  s_mov_b64 exec, 0xffffffff
  buffer_load_dwordx4 v128, s[4:7], s38 offen offset:2048 sc1 lds
  s_mov_b64 exec, -1
  s_add_u32 s38, s38, 10240
P2_nodma_59:
  v_exp_f32 v68, v68
  v_exp_f32 v69, v69
  v_exp_f32 v70, v70
  v_exp_f32 v71, v71
  v_cvt_pk_bf16_f32 v52, v64, v65
  v_cvt_pk_bf16_f32 v53, v66, v67
  v_mfma_f32_32x32x8_bf16 v[80:95], v[34:35], v[18:19], v[80:95]
  v_cvt_pk_bf16_f32 v54, v68, v69
  v_cvt_pk_bf16_f32 v55, v70, v71
  v_exp_f32 v72, v72
  v_exp_f32 v73, v73
  v_exp_f32 v74, v74
  v_exp_f32 v75, v75
  s_waitcnt lgkmcnt(2)
  buffer_store_dwordx4 v[224:227], v128, s[4:7], s71 offen sc1
  v_mfma_f32_32x32x16_bf16 v[96:111], v[40:43], v[52:55], v[96:111]
  v_exp_f32 v76, v76
  v_exp_f32 v77, v77
  v_exp_f32 v78, v78
  v_exp_f32 v79, v79
  v_cvt_pk_bf16_f32 v56, v72, v73
  v_cvt_pk_bf16_f32 v57, v74, v75
  v_cvt_pk_bf16_f32 v58, v76, v77
  v_cvt_pk_bf16_f32 v59, v78, v79
  s_setprio 0
  s_waitcnt lgkmcnt(0)
  v_mfma_f32_32x32x16_bf16 v[64:79], v[24:27], v[12:15], 0
  v_exp_f32 v80, v80
  v_exp_f32 v81, v81
  v_exp_f32 v82, v82
  v_exp_f32 v83, v83
  v_mfma_f32_32x32x16_bf16 v[96:111], v[48:51], v[56:59], v[96:111]
  ds_read_b128 v[36:39], v22 offset:24576
  ds_read_b128 v[44:47], v23 offset:24576
  s_cmp_eq_u32 s42, 1
  s_cbranch_scc0 P2_nodma_60
  s_add_u32 m0, s39, 49152
  s_nop 0
  buffer_load_dwordx4 v128, s[4:7], s38 offen sc1 lds
  buffer_load_dwordx4 v128, s[4:7], s38 offen offset:1024 sc1 lds
  s_mov_b64 exec, 0xffffffff
  buffer_load_dwordx4 v128, s[4:7], s38 offen offset:2048 sc1 lds
  s_mov_b64 exec, -1
  s_add_u32 s38, s38, 10240
P2_nodma_60:
  v_exp_f32 v84, v84
  v_exp_f32 v85, v85
  v_exp_f32 v86, v86
  v_exp_f32 v87, v87
  s_cmp_eq_u32 s76, 0
  s_cbranch_scc1 CVR_none_61
  s_cmp_eq_u32 s76, 2
  s_cbranch_scc1 CVR_B_62
  ds_read_b64_tr_b16 v[184:185], v217 offset:0
  ds_read_b64_tr_b16 v[186:187], v217 offset:2048
  ds_read_b64_tr_b16 v[188:189], v217 offset:64
  ds_read_b64_tr_b16 v[190:191], v217 offset:2112
  ds_read_b64_tr_b16 v[192:193], v217 offset:128
  ds_read_b64_tr_b16 v[194:195], v217 offset:2176
  ds_read_b64_tr_b16 v[196:197], v217 offset:192
  ds_read_b64_tr_b16 v[198:199], v217 offset:2240
  ds_read_b64_tr_b16 v[200:201], v217 offset:256
  ds_read_b64_tr_b16 v[202:203], v217 offset:2304
  ds_read_b64_tr_b16 v[204:205], v217 offset:320
  ds_read_b64_tr_b16 v[206:207], v217 offset:2368
  ds_read_b64_tr_b16 v[208:209], v217 offset:384
  ds_read_b64_tr_b16 v[210:211], v217 offset:2432
  ds_read_b64_tr_b16 v[212:213], v217 offset:448
  ds_read_b64_tr_b16 v[214:215], v217 offset:2496
  s_branch CVR_none_61
CVR_B_62:
  ds_read_b64_tr_b16 v[184:185], v217 offset:0
  ds_read_b64_tr_b16 v[186:187], v217 offset:1024
  ds_read_b64_tr_b16 v[188:189], v217 offset:32
  ds_read_b64_tr_b16 v[190:191], v217 offset:1056
  ds_read_b64_tr_b16 v[192:193], v217 offset:64
  ds_read_b64_tr_b16 v[194:195], v217 offset:1088
  ds_read_b64_tr_b16 v[196:197], v217 offset:96
  ds_read_b64_tr_b16 v[198:199], v217 offset:1120
  ds_read_b64_tr_b16 v[200:201], v217 offset:128
  ds_read_b64_tr_b16 v[202:203], v217 offset:1152
  ds_read_b64_tr_b16 v[204:205], v217 offset:160
  ds_read_b64_tr_b16 v[206:207], v217 offset:1184
  ds_read_b64_tr_b16 v[208:209], v217 offset:192
  ds_read_b64_tr_b16 v[210:211], v217 offset:1216
  ds_read_b64_tr_b16 v[212:213], v217 offset:224
  ds_read_b64_tr_b16 v[214:215], v217 offset:1248
CVR_none_61:
  v_cvt_pk_bf16_f32 v52, v80, v81
  v_cvt_pk_bf16_f32 v53, v82, v83
  v_mfma_f32_32x32x8_bf16 v[64:79], v[32:33], v[16:17], v[64:79]
  v_cvt_pk_bf16_f32 v54, v84, v85
  v_cvt_pk_bf16_f32 v55, v86, v87
  v_exp_f32 v88, v88
  v_exp_f32 v89, v89
  v_exp_f32 v90, v90
  v_exp_f32 v91, v91
  v_mfma_f32_32x32x16_bf16 v[112:127], v[40:43], v[52:55], v[112:127]
  v_exp_f32 v92, v92
  v_exp_f32 v93, v93
  v_exp_f32 v94, v94
  v_exp_f32 v95, v95
  v_cvt_pk_bf16_f32 v56, v88, v89
  v_cvt_pk_bf16_f32 v57, v90, v91
  v_cvt_pk_bf16_f32 v58, v92, v93
  v_cvt_pk_bf16_f32 v59, v94, v95
  s_setprio 1
  v_mfma_f32_32x32x16_bf16 v[80:95], v[24:27], v[60:63], 0
  v_exp_f32 v64, v64
  v_exp_f32 v65, v65
  v_exp_f32 v66, v66
  v_exp_f32 v67, v67
  v_mfma_f32_32x32x16_bf16 v[112:127], v[48:51], v[56:59], v[112:127]
  ds_read_b128 v[28:31], v20 offset:27648
  ds_read_b64 v[34:35], v21 offset:27648
  v_exp_f32 v68, v68
  v_exp_f32 v69, v69
  v_exp_f32 v70, v70
  v_exp_f32 v71, v71
  v_cvt_pk_bf16_f32 v52, v64, v65
  v_cvt_pk_bf16_f32 v53, v66, v67
  v_mfma_f32_32x32x8_bf16 v[80:95], v[32:33], v[18:19], v[80:95]
  v_cvt_pk_bf16_f32 v54, v68, v69
  v_cvt_pk_bf16_f32 v55, v70, v71
  v_exp_f32 v72, v72
  v_exp_f32 v73, v73
  v_exp_f32 v74, v74
  v_exp_f32 v75, v75
  s_waitcnt lgkmcnt(2)
  v_mfma_f32_32x32x16_bf16 v[96:111], v[36:39], v[52:55], v[96:111]
  v_exp_f32 v76, v76
  v_exp_f32 v77, v77
  v_exp_f32 v78, v78
  v_exp_f32 v79, v79
  v_cvt_pk_bf16_f32 v56, v72, v73
  v_cvt_pk_bf16_f32 v57, v74, v75
  v_cvt_pk_bf16_f32 v58, v76, v77
  v_cvt_pk_bf16_f32 v59, v78, v79
  s_setprio 0
  s_waitcnt lgkmcnt(0)
  v_mfma_f32_32x32x16_bf16 v[64:79], v[28:31], v[12:15], 0
  v_exp_f32 v80, v80
  v_exp_f32 v81, v81
  v_exp_f32 v82, v82
  v_exp_f32 v83, v83
  v_mfma_f32_32x32x16_bf16 v[96:111], v[44:47], v[56:59], v[96:111]
  ds_read_b128 v[40:43], v22 offset:27648
  ds_read_b128 v[48:51], v23 offset:27648
  v_exp_f32 v84, v84
  v_exp_f32 v85, v85
  v_exp_f32 v86, v86
  v_exp_f32 v87, v87
  v_cvt_pk_bf16_f32 v52, v80, v81
  v_cvt_pk_bf16_f32 v53, v82, v83
  v_mfma_f32_32x32x8_bf16 v[64:79], v[34:35], v[16:17], v[64:79]
  v_cvt_pk_bf16_f32 v54, v84, v85
  v_cvt_pk_bf16_f32 v55, v86, v87
  v_exp_f32 v88, v88
  v_exp_f32 v89, v89
  v_exp_f32 v90, v90
  v_exp_f32 v91, v91
  s_cmp_eq_u32 s76, 0
  s_cbranch_scc1 CVS_none_63
  buffer_store_dwordx4 v[184:187], v216, s[4:7], s77 offen sc1
  s_add_u32 s77, s77, s78
  buffer_store_dwordx4 v[188:191], v216, s[4:7], s77 offen sc1
  s_add_u32 s77, s77, s78
  buffer_store_dwordx4 v[192:195], v216, s[4:7], s77 offen sc1
  s_add_u32 s77, s77, s78
  buffer_store_dwordx4 v[196:199], v216, s[4:7], s77 offen sc1
  s_add_u32 s77, s77, s78
  buffer_store_dwordx4 v[200:203], v216, s[4:7], s77 offen sc1
  s_add_u32 s77, s77, s78
  buffer_store_dwordx4 v[204:207], v216, s[4:7], s77 offen sc1
  s_add_u32 s77, s77, s78
  buffer_store_dwordx4 v[208:211], v216, s[4:7], s77 offen sc1
  s_add_u32 s77, s77, s78
  buffer_store_dwordx4 v[212:215], v216, s[4:7], s77 offen sc1
  s_add_u32 s77, s77, s78
CVS_none_63:
  v_mfma_f32_32x32x16_bf16 v[112:127], v[36:39], v[52:55], v[112:127]
  v_exp_f32 v92, v92
  v_exp_f32 v93, v93
  v_exp_f32 v94, v94
  v_exp_f32 v95, v95
  v_cvt_pk_bf16_f32 v56, v88, v89
  v_cvt_pk_bf16_f32 v57, v90, v91
  v_cvt_pk_bf16_f32 v58, v92, v93
  v_cvt_pk_bf16_f32 v59, v94, v95
  s_setprio 1
  v_mfma_f32_32x32x16_bf16 v[80:95], v[28:31], v[60:63], 0
  v_exp_f32 v64, v64
  v_exp_f32 v65, v65
  v_exp_f32 v66, v66
  v_exp_f32 v67, v67
  v_mfma_f32_32x32x16_bf16 v[112:127], v[44:47], v[56:59], v[112:127]
  ds_read_b128 v[24:27], v20 offset:30720
  ds_read_b64 v[32:33], v21 offset:30720
  v_exp_f32 v68, v68
  v_exp_f32 v69, v69
  v_exp_f32 v70, v70
  v_exp_f32 v71, v71
  v_cvt_pk_bf16_f32 v52, v64, v65
  v_cvt_pk_bf16_f32 v53, v66, v67
  v_mfma_f32_32x32x8_bf16 v[80:95], v[34:35], v[18:19], v[80:95]
  v_cvt_pk_bf16_f32 v54, v68, v69
  v_cvt_pk_bf16_f32 v55, v70, v71
  v_exp_f32 v72, v72
  v_exp_f32 v73, v73
  v_exp_f32 v74, v74
  v_exp_f32 v75, v75
  s_waitcnt lgkmcnt(2)
  v_mfma_f32_32x32x16_bf16 v[96:111], v[40:43], v[52:55], v[96:111]
  v_exp_f32 v76, v76
  v_exp_f32 v77, v77
  v_exp_f32 v78, v78
  v_exp_f32 v79, v79
  v_cvt_pk_bf16_f32 v56, v72, v73
  v_cvt_pk_bf16_f32 v57, v74, v75
  v_cvt_pk_bf16_f32 v58, v76, v77
  v_cvt_pk_bf16_f32 v59, v78, v79
  s_setprio 0
  s_waitcnt lgkmcnt(0)
  v_mfma_f32_32x32x16_bf16 v[64:79], v[24:27], v[12:15], 0
  v_exp_f32 v80, v80
  v_exp_f32 v81, v81
  v_exp_f32 v82, v82
  v_exp_f32 v83, v83
  v_mfma_f32_32x32x16_bf16 v[96:111], v[48:51], v[56:59], v[96:111]
  ds_read_b128 v[36:39], v22 offset:30720
  ds_read_b128 v[44:47], v23 offset:30720
  v_exp_f32 v84, v84
  v_exp_f32 v85, v85
  v_exp_f32 v86, v86
  v_exp_f32 v87, v87
  v_cvt_pk_bf16_f32 v52, v80, v81
  v_cvt_pk_bf16_f32 v53, v82, v83
  v_mfma_f32_32x32x8_bf16 v[64:79], v[32:33], v[16:17], v[64:79]
  v_cvt_pk_bf16_f32 v54, v84, v85
  v_cvt_pk_bf16_f32 v55, v86, v87
  v_exp_f32 v88, v88
  v_exp_f32 v89, v89
  v_exp_f32 v90, v90
  v_exp_f32 v91, v91
  v_mfma_f32_32x32x16_bf16 v[112:127], v[40:43], v[52:55], v[112:127]
  v_exp_f32 v92, v92
  v_exp_f32 v93, v93
  v_exp_f32 v94, v94
  v_exp_f32 v95, v95
  v_cvt_pk_bf16_f32 v56, v88, v89
  v_cvt_pk_bf16_f32 v57, v90, v91
  v_cvt_pk_bf16_f32 v58, v92, v93
  v_cvt_pk_bf16_f32 v59, v94, v95
  s_setprio 1
  v_mfma_f32_32x32x16_bf16 v[80:95], v[24:27], v[60:63], 0
  v_exp_f32 v64, v64
  v_exp_f32 v65, v65
  v_exp_f32 v66, v66
  v_exp_f32 v67, v67
  v_mfma_f32_32x32x16_bf16 v[112:127], v[48:51], v[56:59], v[112:127]
  ds_read_b128 v[28:31], v20 offset:33792
  ds_read_b64 v[34:35], v21 offset:33792
  v_exp_f32 v68, v68
  v_exp_f32 v69, v69
  v_exp_f32 v70, v70
  v_exp_f32 v71, v71
  v_cvt_pk_bf16_f32 v52, v64, v65
  v_cvt_pk_bf16_f32 v53, v66, v67
  v_mfma_f32_32x32x8_bf16 v[80:95], v[32:33], v[18:19], v[80:95]
  v_cvt_pk_bf16_f32 v54, v68, v69
  v_cvt_pk_bf16_f32 v55, v70, v71
  v_exp_f32 v72, v72
  v_exp_f32 v73, v73
  v_exp_f32 v74, v74
  v_exp_f32 v75, v75
  s_waitcnt lgkmcnt(2)
  v_mfma_f32_32x32x16_bf16 v[96:111], v[36:39], v[52:55], v[96:111]
  v_exp_f32 v76, v76
  v_exp_f32 v77, v77
  v_exp_f32 v78, v78
  v_exp_f32 v79, v79
  v_cvt_pk_bf16_f32 v56, v72, v73
  v_cvt_pk_bf16_f32 v57, v74, v75
  v_cvt_pk_bf16_f32 v58, v76, v77
  v_cvt_pk_bf16_f32 v59, v78, v79
  s_setprio 0
  s_waitcnt lgkmcnt(0)
  v_mfma_f32_32x32x16_bf16 v[64:79], v[28:31], v[12:15], 0
  v_exp_f32 v80, v80
  v_exp_f32 v81, v81
  v_exp_f32 v82, v82
  v_exp_f32 v83, v83
  v_mfma_f32_32x32x16_bf16 v[96:111], v[44:47], v[56:59], v[96:111]
  ds_read_b128 v[40:43], v22 offset:33792
  ds_read_b128 v[48:51], v23 offset:33792
  v_exp_f32 v84, v84
  v_exp_f32 v85, v85
  v_exp_f32 v86, v86
  v_exp_f32 v87, v87
  v_cvt_pk_bf16_f32 v52, v80, v81
  v_cvt_pk_bf16_f32 v53, v82, v83
  v_mfma_f32_32x32x8_bf16 v[64:79], v[34:35], v[16:17], v[64:79]
  v_cvt_pk_bf16_f32 v54, v84, v85
  v_cvt_pk_bf16_f32 v55, v86, v87
  v_exp_f32 v88, v88
  v_exp_f32 v89, v89
  v_exp_f32 v90, v90
  v_exp_f32 v91, v91
  v_mfma_f32_32x32x16_bf16 v[112:127], v[36:39], v[52:55], v[112:127]
  v_exp_f32 v92, v92
  v_exp_f32 v93, v93
  v_exp_f32 v94, v94
  v_exp_f32 v95, v95
  v_cvt_pk_bf16_f32 v56, v88, v89
  v_cvt_pk_bf16_f32 v57, v90, v91
  v_cvt_pk_bf16_f32 v58, v92, v93
  v_cvt_pk_bf16_f32 v59, v94, v95
  s_waitcnt vmcnt(0)
  s_barrier
  s_setprio 1
  v_mfma_f32_32x32x16_bf16 v[80:95], v[28:31], v[60:63], 0
  v_exp_f32 v64, v64
  v_exp_f32 v65, v65
  v_exp_f32 v66, v66
  v_exp_f32 v67, v67
  v_mfma_f32_32x32x16_bf16 v[112:127], v[44:47], v[56:59], v[112:127]
  ds_read_b128 v[24:27], v20 offset:49152
  ds_read_b64 v[32:33], v21 offset:49152
  s_cmp_eq_u32 s42, 0
  s_cbranch_scc0 P2_nodma_64
  s_add_u32 m0, s39, 0
  s_nop 0
  buffer_load_dwordx4 v128, s[4:7], s38 offen sc1 lds
  buffer_load_dwordx4 v128, s[4:7], s38 offen offset:1024 sc1 lds
  s_mov_b64 exec, 0xffffffff
  buffer_load_dwordx4 v128, s[4:7], s38 offen offset:2048 sc1 lds
  s_mov_b64 exec, -1
  s_add_u32 s38, s38, 10240
P2_nodma_64:
  v_exp_f32 v68, v68
  v_exp_f32 v69, v69
  v_exp_f32 v70, v70
  v_exp_f32 v71, v71
  v_cvt_pk_bf16_f32 v52, v64, v65
  v_cvt_pk_bf16_f32 v53, v66, v67
  v_mfma_f32_32x32x8_bf16 v[80:95], v[34:35], v[18:19], v[80:95]
  v_cvt_pk_bf16_f32 v54, v68, v69
  v_cvt_pk_bf16_f32 v55, v70, v71
  v_exp_f32 v72, v72
  v_exp_f32 v73, v73
  v_exp_f32 v74, v74
  v_exp_f32 v75, v75
  s_waitcnt lgkmcnt(2)
  v_mfma_f32_32x32x16_bf16 v[96:111], v[40:43], v[52:55], v[96:111]
  v_exp_f32 v76, v76
  v_exp_f32 v77, v77
  v_exp_f32 v78, v78
  v_exp_f32 v79, v79
  v_cvt_pk_bf16_f32 v56, v72, v73
  v_cvt_pk_bf16_f32 v57, v74, v75
  v_cvt_pk_bf16_f32 v58, v76, v77
  v_cvt_pk_bf16_f32 v59, v78, v79
  s_setprio 0
  s_waitcnt lgkmcnt(0)
  v_mfma_f32_32x32x16_bf16 v[64:79], v[24:27], v[12:15], 0
  v_exp_f32 v80, v80
  v_exp_f32 v81, v81
  v_exp_f32 v82, v82
  v_exp_f32 v83, v83
  v_mfma_f32_32x32x16_bf16 v[96:111], v[48:51], v[56:59], v[96:111]
  ds_read_b128 v[36:39], v22 offset:49152
  ds_read_b128 v[44:47], v23 offset:49152
  s_cmp_eq_u32 s42, 1
  s_cbranch_scc0 P2_nodma_65
  s_add_u32 m0, s39, 0
  s_nop 0
  buffer_load_dwordx4 v128, s[4:7], s38 offen sc1 lds
  buffer_load_dwordx4 v128, s[4:7], s38 offen offset:1024 sc1 lds
  s_mov_b64 exec, 0xffffffff
  buffer_load_dwordx4 v128, s[4:7], s38 offen offset:2048 sc1 lds
  s_mov_b64 exec, -1
  s_add_u32 s38, s38, 10240
P2_nodma_65:
  v_exp_f32 v84, v84
  v_exp_f32 v85, v85
  v_exp_f32 v86, v86
  v_exp_f32 v87, v87
  v_cvt_pk_bf16_f32 v52, v80, v81
  v_cvt_pk_bf16_f32 v53, v82, v83
  v_mfma_f32_32x32x8_bf16 v[64:79], v[32:33], v[16:17], v[64:79]
  v_cvt_pk_bf16_f32 v54, v84, v85
  v_cvt_pk_bf16_f32 v55, v86, v87
  v_exp_f32 v88, v88
  v_exp_f32 v89, v89
  v_exp_f32 v90, v90
  v_exp_f32 v91, v91
  s_cmp_eq_u32 s32, 0
  s_cbranch_scc0 cflag_66
  s_lshl_b32 s54, s2, 7
  s_add_u32 s54, s54, 69696
  v_mov_b32 v220, s35
  v_mov_b32 v221, 0
  s_mov_b64 exec, 1
  buffer_store_dword v220, v221, s[4:7], s54 offen sc1
  s_mov_b64 exec, -1
cflag_66:
  v_mfma_f32_32x32x16_bf16 v[112:127], v[40:43], v[52:55], v[112:127]
  v_exp_f32 v92, v92
  v_exp_f32 v93, v93
  v_exp_f32 v94, v94
  v_exp_f32 v95, v95
  v_cvt_pk_bf16_f32 v56, v88, v89
  v_cvt_pk_bf16_f32 v57, v90, v91
  v_cvt_pk_bf16_f32 v58, v92, v93
  v_cvt_pk_bf16_f32 v59, v94, v95
  s_setprio 1
  v_mfma_f32_32x32x16_bf16 v[80:95], v[24:27], v[60:63], 0
  v_exp_f32 v64, v64
  v_exp_f32 v65, v65
  v_exp_f32 v66, v66
  v_exp_f32 v67, v67
  v_mfma_f32_32x32x16_bf16 v[112:127], v[48:51], v[56:59], v[112:127]
  ds_read_b128 v[28:31], v20 offset:52224
  ds_read_b64 v[34:35], v21 offset:52224
  v_exp_f32 v68, v68
  v_exp_f32 v69, v69
  v_exp_f32 v70, v70
  v_exp_f32 v71, v71
  v_cvt_pk_bf16_f32 v52, v64, v65
  v_cvt_pk_bf16_f32 v53, v66, v67
  v_mfma_f32_32x32x8_bf16 v[80:95], v[32:33], v[18:19], v[80:95]
  v_cvt_pk_bf16_f32 v54, v68, v69
  v_cvt_pk_bf16_f32 v55, v70, v71
  v_exp_f32 v72, v72
  v_exp_f32 v73, v73
  v_exp_f32 v74, v74
  v_exp_f32 v75, v75
  s_waitcnt lgkmcnt(2)
  v_mfma_f32_32x32x16_bf16 v[96:111], v[36:39], v[52:55], v[96:111]
  v_exp_f32 v76, v76
  v_exp_f32 v77, v77
  v_exp_f32 v78, v78
  v_exp_f32 v79, v79
  v_cvt_pk_bf16_f32 v56, v72, v73
  v_cvt_pk_bf16_f32 v57, v74, v75
  v_cvt_pk_bf16_f32 v58, v76, v77
  v_cvt_pk_bf16_f32 v59, v78, v79
  s_setprio 0
  s_waitcnt lgkmcnt(0)
  v_mfma_f32_32x32x16_bf16 v[64:79], v[28:31], v[12:15], 0
  v_exp_f32 v80, v80
  v_exp_f32 v81, v81
  v_exp_f32 v82, v82
  v_exp_f32 v83, v83
  v_mfma_f32_32x32x16_bf16 v[96:111], v[44:47], v[56:59], v[96:111]
  ds_read_b128 v[40:43], v22 offset:52224
  ds_read_b128 v[48:51], v23 offset:52224
  v_exp_f32 v84, v84
  v_exp_f32 v85, v85
  v_exp_f32 v86, v86
  v_exp_f32 v87, v87
  v_cvt_pk_bf16_f32 v52, v80, v81
  v_cvt_pk_bf16_f32 v53, v82, v83
  v_mfma_f32_32x32x8_bf16 v[64:79], v[34:35], v[16:17], v[64:79]
  v_cvt_pk_bf16_f32 v54, v84, v85
  v_cvt_pk_bf16_f32 v55, v86, v87
  v_exp_f32 v88, v88
  v_exp_f32 v89, v89
  v_exp_f32 v90, v90
  v_exp_f32 v91, v91
  v_mfma_f32_32x32x16_bf16 v[112:127], v[36:39], v[52:55], v[112:127]
  v_exp_f32 v92, v92
  v_exp_f32 v93, v93
  v_exp_f32 v94, v94
  v_exp_f32 v95, v95
  v_cvt_pk_bf16_f32 v56, v88, v89
  v_cvt_pk_bf16_f32 v57, v90, v91
  v_cvt_pk_bf16_f32 v58, v92, v93
  v_cvt_pk_bf16_f32 v59, v94, v95
  s_setprio 1
  v_mfma_f32_32x32x16_bf16 v[80:95], v[28:31], v[60:63], 0
  v_exp_f32 v64, v64
  v_exp_f32 v65, v65
  v_exp_f32 v66, v66
  v_exp_f32 v67, v67
  v_mfma_f32_32x32x16_bf16 v[112:127], v[44:47], v[56:59], v[112:127]
  ds_read_b128 v[24:27], v20 offset:55296
  ds_read_b64 v[32:33], v21 offset:55296
  v_exp_f32 v68, v68
  v_exp_f32 v69, v69
  v_exp_f32 v70, v70
  v_exp_f32 v71, v71
  v_cvt_pk_bf16_f32 v52, v64, v65
  v_cvt_pk_bf16_f32 v53, v66, v67
  v_mfma_f32_32x32x8_bf16 v[80:95], v[34:35], v[18:19], v[80:95]
  v_cvt_pk_bf16_f32 v54, v68, v69
  v_cvt_pk_bf16_f32 v55, v70, v71
  v_exp_f32 v72, v72
  v_exp_f32 v73, v73
  v_exp_f32 v74, v74
  v_exp_f32 v75, v75
  s_waitcnt lgkmcnt(2)
  v_mfma_f32_32x32x16_bf16 v[96:111], v[40:43], v[52:55], v[96:111]
  v_exp_f32 v76, v76
  v_exp_f32 v77, v77
  v_exp_f32 v78, v78
  v_exp_f32 v79, v79
  v_cvt_pk_bf16_f32 v56, v72, v73
  v_cvt_pk_bf16_f32 v57, v74, v75
  v_cvt_pk_bf16_f32 v58, v76, v77
  v_cvt_pk_bf16_f32 v59, v78, v79
  s_setprio 0
  s_waitcnt lgkmcnt(0)
  v_mfma_f32_32x32x16_bf16 v[64:79], v[24:27], v[12:15], 0
  v_exp_f32 v80, v80
  v_exp_f32 v81, v81
  v_exp_f32 v82, v82
  v_exp_f32 v83, v83
  v_mfma_f32_32x32x16_bf16 v[96:111], v[48:51], v[56:59], v[96:111]
  ds_read_b128 v[36:39], v22 offset:55296
  ds_read_b128 v[44:47], v23 offset:55296
  v_exp_f32 v84, v84
  v_exp_f32 v85, v85
  v_exp_f32 v86, v86
  v_exp_f32 v87, v87
  v_cvt_pk_bf16_f32 v52, v80, v81
  v_cvt_pk_bf16_f32 v53, v82, v83
  v_mfma_f32_32x32x8_bf16 v[64:79], v[32:33], v[16:17], v[64:79]
  v_cvt_pk_bf16_f32 v54, v84, v85
  v_cvt_pk_bf16_f32 v55, v86, v87
  v_exp_f32 v88, v88
  v_exp_f32 v89, v89
  v_exp_f32 v90, v90
  v_exp_f32 v91, v91
  v_mfma_f32_32x32x16_bf16 v[112:127], v[40:43], v[52:55], v[112:127]
  v_exp_f32 v92, v92
  v_exp_f32 v93, v93
  v_exp_f32 v94, v94
  v_exp_f32 v95, v95
  v_cvt_pk_bf16_f32 v56, v88, v89
  v_cvt_pk_bf16_f32 v57, v90, v91
  v_cvt_pk_bf16_f32 v58, v92, v93
  v_cvt_pk_bf16_f32 v59, v94, v95
  s_setprio 1
  v_mfma_f32_32x32x16_bf16 v[80:95], v[24:27], v[60:63], 0
  v_exp_f32 v64, v64
  v_exp_f32 v65, v65
  v_exp_f32 v66, v66
  v_exp_f32 v67, v67
  v_mfma_f32_32x32x16_bf16 v[112:127], v[48:51], v[56:59], v[112:127]
  ds_read_b128 v[28:31], v20 offset:58368
  ds_read_b64 v[34:35], v21 offset:58368
  v_exp_f32 v68, v68
  v_exp_f32 v69, v69
  v_exp_f32 v70, v70
  v_exp_f32 v71, v71
  v_cvt_pk_bf16_f32 v52, v64, v65
  v_cvt_pk_bf16_f32 v53, v66, v67
  v_mfma_f32_32x32x8_bf16 v[80:95], v[32:33], v[18:19], v[80:95]
  v_cvt_pk_bf16_f32 v54, v68, v69
  v_cvt_pk_bf16_f32 v55, v70, v71
  v_exp_f32 v72, v72
  v_exp_f32 v73, v73
  v_exp_f32 v74, v74
  v_exp_f32 v75, v75
  s_waitcnt lgkmcnt(2)
  v_mfma_f32_32x32x16_bf16 v[96:111], v[36:39], v[52:55], v[96:111]
  v_exp_f32 v76, v76
  v_exp_f32 v77, v77
  v_exp_f32 v78, v78
  v_exp_f32 v79, v79
  v_cvt_pk_bf16_f32 v56, v72, v73
  v_cvt_pk_bf16_f32 v57, v74, v75
  v_cvt_pk_bf16_f32 v58, v76, v77
  v_cvt_pk_bf16_f32 v59, v78, v79
  s_setprio 0
  s_waitcnt lgkmcnt(0)
  v_mfma_f32_32x32x16_bf16 v[64:79], v[28:31], v[12:15], 0
  v_exp_f32 v80, v80
  v_exp_f32 v81, v81
  v_exp_f32 v82, v82
  v_exp_f32 v83, v83
  v_mfma_f32_32x32x16_bf16 v[96:111], v[44:47], v[56:59], v[96:111]
  ds_read_b128 v[40:43], v22 offset:58368
  ds_read_b128 v[48:51], v23 offset:58368
  v_exp_f32 v84, v84
  v_exp_f32 v85, v85
  v_exp_f32 v86, v86
  v_exp_f32 v87, v87
  v_cvt_pk_bf16_f32 v52, v80, v81
  v_cvt_pk_bf16_f32 v53, v82, v83
  v_mfma_f32_32x32x8_bf16 v[64:79], v[34:35], v[16:17], v[64:79]
  v_cvt_pk_bf16_f32 v54, v84, v85
  v_cvt_pk_bf16_f32 v55, v86, v87
  v_exp_f32 v88, v88
  v_exp_f32 v89, v89
  v_exp_f32 v90, v90
  v_exp_f32 v91, v91
  v_mfma_f32_32x32x16_bf16 v[112:127], v[36:39], v[52:55], v[112:127]
  v_exp_f32 v92, v92
  v_exp_f32 v93, v93
  v_exp_f32 v94, v94
  v_exp_f32 v95, v95
  v_cvt_pk_bf16_f32 v56, v88, v89
  v_cvt_pk_bf16_f32 v57, v90, v91
  v_cvt_pk_bf16_f32 v58, v92, v93
  v_cvt_pk_bf16_f32 v59, v94, v95
  s_waitcnt vmcnt(0)
  s_barrier
  s_setprio 1
  v_mfma_f32_32x32x16_bf16 v[80:95], v[28:31], v[60:63], 0
  v_exp_f32 v64, v64
  v_exp_f32 v65, v65
  v_exp_f32 v66, v66
  v_exp_f32 v67, v67
  v_mfma_f32_32x32x16_bf16 v[112:127], v[44:47], v[56:59], v[112:127]
  ds_read_b128 v[24:27], v20 offset:0
  ds_read_b64 v[32:33], v21 offset:0
  s_cmp_eq_u32 s42, 0
  s_cbranch_scc0 P2_nodma_67
  s_add_u32 m0, s39, 24576
  s_nop 0
  buffer_load_dwordx4 v128, s[4:7], s38 offen sc1 lds
  buffer_load_dwordx4 v128, s[4:7], s38 offen offset:1024 sc1 lds
  s_mov_b64 exec, 0xffffffff
  buffer_load_dwordx4 v128, s[4:7], s38 offen offset:2048 sc1 lds
  s_mov_b64 exec, -1
  s_add_u32 s38, s38, 10240
P2_nodma_67:
  v_exp_f32 v68, v68
  v_exp_f32 v69, v69
  v_exp_f32 v70, v70
  v_exp_f32 v71, v71
  v_cvt_pk_bf16_f32 v52, v64, v65
  v_cvt_pk_bf16_f32 v53, v66, v67
  v_mfma_f32_32x32x8_bf16 v[80:95], v[34:35], v[18:19], v[80:95]
  v_cvt_pk_bf16_f32 v54, v68, v69
  v_cvt_pk_bf16_f32 v55, v70, v71
  v_exp_f32 v72, v72
  v_exp_f32 v73, v73
  v_exp_f32 v74, v74
  v_exp_f32 v75, v75
  s_waitcnt lgkmcnt(2)
  v_mfma_f32_32x32x16_bf16 v[96:111], v[40:43], v[52:55], v[96:111]
  v_exp_f32 v76, v76
  v_exp_f32 v77, v77
  v_exp_f32 v78, v78
  v_exp_f32 v79, v79
  v_cvt_pk_bf16_f32 v56, v72, v73
  v_cvt_pk_bf16_f32 v57, v74, v75
  v_cvt_pk_bf16_f32 v58, v76, v77
  v_cvt_pk_bf16_f32 v59, v78, v79
  s_setprio 0
  s_waitcnt lgkmcnt(0)
  v_mfma_f32_32x32x16_bf16 v[64:79], v[24:27], v[12:15], 0
  v_exp_f32 v80, v80
  v_exp_f32 v81, v81
  v_exp_f32 v82, v82
  v_exp_f32 v83, v83
  v_mfma_f32_32x32x16_bf16 v[96:111], v[48:51], v[56:59], v[96:111]
  ds_read_b128 v[36:39], v22 offset:0
  ds_read_b128 v[44:47], v23 offset:0
  s_cmp_eq_u32 s42, 1
  s_cbranch_scc0 P2_nodma_68
  s_add_u32 m0, s39, 24576
  s_nop 0
  buffer_load_dwordx4 v128, s[4:7], s38 offen sc1 lds
  buffer_load_dwordx4 v128, s[4:7], s38 offen offset:1024 sc1 lds
  s_mov_b64 exec, 0xffffffff
  buffer_load_dwordx4 v128, s[4:7], s38 offen offset:2048 sc1 lds
  s_mov_b64 exec, -1
  s_add_u32 s38, s38, 10240
P2_nodma_68:
  v_exp_f32 v84, v84
  v_exp_f32 v85, v85
  v_exp_f32 v86, v86
  v_exp_f32 v87, v87
  v_cvt_pk_bf16_f32 v52, v80, v81
  v_cvt_pk_bf16_f32 v53, v82, v83
  v_mfma_f32_32x32x8_bf16 v[64:79], v[32:33], v[16:17], v[64:79]
  v_cvt_pk_bf16_f32 v54, v84, v85
  v_cvt_pk_bf16_f32 v55, v86, v87
  v_exp_f32 v88, v88
  v_exp_f32 v89, v89
  v_exp_f32 v90, v90
  v_exp_f32 v91, v91
  v_mfma_f32_32x32x16_bf16 v[112:127], v[40:43], v[52:55], v[112:127]
  v_exp_f32 v92, v92
  v_exp_f32 v93, v93
  v_exp_f32 v94, v94
  v_exp_f32 v95, v95
  v_cvt_pk_bf16_f32 v56, v88, v89
  v_cvt_pk_bf16_f32 v57, v90, v91
  v_cvt_pk_bf16_f32 v58, v92, v93
  v_cvt_pk_bf16_f32 v59, v94, v95
  s_setprio 1
  v_mfma_f32_32x32x16_bf16 v[80:95], v[24:27], v[60:63], 0
  v_exp_f32 v64, v64
  v_exp_f32 v65, v65
  v_exp_f32 v66, v66
  v_exp_f32 v67, v67
  v_mfma_f32_32x32x16_bf16 v[112:127], v[48:51], v[56:59], v[112:127]
  ds_read_b128 v[28:31], v20 offset:3072
  ds_read_b64 v[34:35], v21 offset:3072
  v_exp_f32 v68, v68
  v_exp_f32 v69, v69
  v_exp_f32 v70, v70
  v_exp_f32 v71, v71
  v_cvt_pk_bf16_f32 v52, v64, v65
  v_cvt_pk_bf16_f32 v53, v66, v67
  v_mfma_f32_32x32x8_bf16 v[80:95], v[32:33], v[18:19], v[80:95]
  v_cvt_pk_bf16_f32 v54, v68, v69
  v_cvt_pk_bf16_f32 v55, v70, v71
  v_exp_f32 v72, v72
  v_exp_f32 v73, v73
  v_exp_f32 v74, v74
  v_exp_f32 v75, v75
  s_waitcnt lgkmcnt(2)
  v_mfma_f32_32x32x16_bf16 v[96:111], v[36:39], v[52:55], v[96:111]
  v_exp_f32 v76, v76
  v_exp_f32 v77, v77
  v_exp_f32 v78, v78
  v_exp_f32 v79, v79
  v_cvt_pk_bf16_f32 v56, v72, v73
  v_cvt_pk_bf16_f32 v57, v74, v75
  v_cvt_pk_bf16_f32 v58, v76, v77
  v_cvt_pk_bf16_f32 v59, v78, v79
  s_setprio 0
  s_waitcnt lgkmcnt(0)
  v_mfma_f32_32x32x16_bf16 v[64:79], v[28:31], v[12:15], 0
  v_exp_f32 v80, v80
  v_exp_f32 v81, v81
  v_exp_f32 v82, v82
  v_exp_f32 v83, v83
  v_mfma_f32_32x32x16_bf16 v[96:111], v[44:47], v[56:59], v[96:111]
  ds_read_b128 v[40:43], v22 offset:3072
  ds_read_b128 v[48:51], v23 offset:3072
  v_exp_f32 v84, v84
  v_exp_f32 v85, v85
  v_exp_f32 v86, v86
  v_exp_f32 v87, v87
  v_cvt_pk_bf16_f32 v52, v80, v81
  v_cvt_pk_bf16_f32 v53, v82, v83
  v_mfma_f32_32x32x8_bf16 v[64:79], v[34:35], v[16:17], v[64:79]
  v_cvt_pk_bf16_f32 v54, v84, v85
  v_cvt_pk_bf16_f32 v55, v86, v87
  v_exp_f32 v88, v88
  v_exp_f32 v89, v89
  v_exp_f32 v90, v90
  v_exp_f32 v91, v91
  s_cmp_eq_u32 s32, 0
  s_cbranch_scc0 cchk0_69
  s_mov_b32 s54, 69696
  buffer_load_dword v221, v228, s[4:7], s54 offen sc1
  s_mov_b32 s54, 77888
  buffer_load_dword v222, v228, s[4:7], s54 offen sc1
  s_mov_b32 s54, 86080
  buffer_load_dword v223, v228, s[4:7], s54 offen sc1
  s_mov_b32 s54, 94272
  buffer_load_dword v224, v228, s[4:7], s54 offen sc1
cchk0_69:
  v_mfma_f32_32x32x16_bf16 v[112:127], v[36:39], v[52:55], v[112:127]
  v_exp_f32 v92, v92
  v_exp_f32 v93, v93
  v_exp_f32 v94, v94
  v_exp_f32 v95, v95
  v_cvt_pk_bf16_f32 v56, v88, v89
  v_cvt_pk_bf16_f32 v57, v90, v91
  v_cvt_pk_bf16_f32 v58, v92, v93
  v_cvt_pk_bf16_f32 v59, v94, v95
  s_setprio 1
  v_mfma_f32_32x32x16_bf16 v[80:95], v[28:31], v[60:63], 0
  v_exp_f32 v64, v64
  v_exp_f32 v65, v65
  v_exp_f32 v66, v66
  v_exp_f32 v67, v67
  v_mfma_f32_32x32x16_bf16 v[112:127], v[44:47], v[56:59], v[112:127]
  ds_read_b128 v[24:27], v20 offset:6144
  ds_read_b64 v[32:33], v21 offset:6144
  v_exp_f32 v68, v68
  v_exp_f32 v69, v69
  v_exp_f32 v70, v70
  v_exp_f32 v71, v71
  v_cvt_pk_bf16_f32 v52, v64, v65
  v_cvt_pk_bf16_f32 v53, v66, v67
  v_mfma_f32_32x32x8_bf16 v[80:95], v[34:35], v[18:19], v[80:95]
  v_cvt_pk_bf16_f32 v54, v68, v69
  v_cvt_pk_bf16_f32 v55, v70, v71
  v_exp_f32 v72, v72
  v_exp_f32 v73, v73
  v_exp_f32 v74, v74
  v_exp_f32 v75, v75
  s_waitcnt lgkmcnt(2)
  v_mfma_f32_32x32x16_bf16 v[96:111], v[40:43], v[52:55], v[96:111]
  v_exp_f32 v76, v76
  v_exp_f32 v77, v77
  v_exp_f32 v78, v78
  v_exp_f32 v79, v79
  v_cvt_pk_bf16_f32 v56, v72, v73
  v_cvt_pk_bf16_f32 v57, v74, v75
  v_cvt_pk_bf16_f32 v58, v76, v77
  v_cvt_pk_bf16_f32 v59, v78, v79
  s_setprio 0
  s_waitcnt lgkmcnt(0)
  v_mfma_f32_32x32x16_bf16 v[64:79], v[24:27], v[12:15], 0
  v_exp_f32 v80, v80
  v_exp_f32 v81, v81
  v_exp_f32 v82, v82
  v_exp_f32 v83, v83
  v_mfma_f32_32x32x16_bf16 v[96:111], v[48:51], v[56:59], v[96:111]
  ds_read_b128 v[36:39], v22 offset:6144
  ds_read_b128 v[44:47], v23 offset:6144
  v_exp_f32 v84, v84
  v_exp_f32 v85, v85
  v_exp_f32 v86, v86
  v_exp_f32 v87, v87
  v_cvt_pk_bf16_f32 v52, v80, v81
  v_cvt_pk_bf16_f32 v53, v82, v83
  v_mfma_f32_32x32x8_bf16 v[64:79], v[32:33], v[16:17], v[64:79]
  v_cvt_pk_bf16_f32 v54, v84, v85
  v_cvt_pk_bf16_f32 v55, v86, v87
  v_exp_f32 v88, v88
  v_exp_f32 v89, v89
  v_exp_f32 v90, v90
  v_exp_f32 v91, v91
  v_mfma_f32_32x32x16_bf16 v[112:127], v[40:43], v[52:55], v[112:127]
  v_exp_f32 v92, v92
  v_exp_f32 v93, v93
  v_exp_f32 v94, v94
  v_exp_f32 v95, v95
  v_cvt_pk_bf16_f32 v56, v88, v89
  v_cvt_pk_bf16_f32 v57, v90, v91
  v_cvt_pk_bf16_f32 v58, v92, v93
  v_cvt_pk_bf16_f32 v59, v94, v95
  s_setprio 1
  v_mfma_f32_32x32x16_bf16 v[80:95], v[24:27], v[60:63], 0
  v_exp_f32 v64, v64
  v_exp_f32 v65, v65
  v_exp_f32 v66, v66
  v_exp_f32 v67, v67
  v_mfma_f32_32x32x16_bf16 v[112:127], v[48:51], v[56:59], v[112:127]
  ds_read_b128 v[28:31], v20 offset:9216
  ds_read_b64 v[34:35], v21 offset:9216
  v_exp_f32 v68, v68
  v_exp_f32 v69, v69
  v_exp_f32 v70, v70
  v_exp_f32 v71, v71
  v_cvt_pk_bf16_f32 v52, v64, v65
  v_cvt_pk_bf16_f32 v53, v66, v67
  v_mfma_f32_32x32x8_bf16 v[80:95], v[32:33], v[18:19], v[80:95]
  v_cvt_pk_bf16_f32 v54, v68, v69
  v_cvt_pk_bf16_f32 v55, v70, v71
  v_exp_f32 v72, v72
  v_exp_f32 v73, v73
  v_exp_f32 v74, v74
  v_exp_f32 v75, v75
  s_waitcnt lgkmcnt(2)
  v_mfma_f32_32x32x16_bf16 v[96:111], v[36:39], v[52:55], v[96:111]
  v_exp_f32 v76, v76
  v_exp_f32 v77, v77
  v_exp_f32 v78, v78
  v_exp_f32 v79, v79
  v_cvt_pk_bf16_f32 v56, v72, v73
  v_cvt_pk_bf16_f32 v57, v74, v75
  v_cvt_pk_bf16_f32 v58, v76, v77
  v_cvt_pk_bf16_f32 v59, v78, v79
  s_setprio 0
  s_waitcnt lgkmcnt(0)
  v_mfma_f32_32x32x16_bf16 v[64:79], v[28:31], v[12:15], 0
  v_exp_f32 v80, v80
  v_exp_f32 v81, v81
  v_exp_f32 v82, v82
  v_exp_f32 v83, v83
  v_mfma_f32_32x32x16_bf16 v[96:111], v[44:47], v[56:59], v[96:111]
  ds_read_b128 v[40:43], v22 offset:9216
  ds_read_b128 v[48:51], v23 offset:9216
  v_exp_f32 v84, v84
  v_exp_f32 v85, v85
  v_exp_f32 v86, v86
  v_exp_f32 v87, v87
  v_cvt_pk_bf16_f32 v52, v80, v81
  v_cvt_pk_bf16_f32 v53, v82, v83
  v_mfma_f32_32x32x8_bf16 v[64:79], v[34:35], v[16:17], v[64:79]
  v_cvt_pk_bf16_f32 v54, v84, v85
  v_cvt_pk_bf16_f32 v55, v86, v87
  v_exp_f32 v88, v88
  v_exp_f32 v89, v89
  v_exp_f32 v90, v90
  v_exp_f32 v91, v91
  s_cmp_eq_u32 s32, 0
  s_cbranch_scc0 cchk_70
  s_mov_b32 s55, 0
  s_branch ccmp_73
cpoll_71:
  s_mov_b32 s54, 69696
  buffer_load_dword v221, v228, s[4:7], s54 offen sc1
  s_mov_b32 s54, 77888
  buffer_load_dword v222, v228, s[4:7], s54 offen sc1
  s_mov_b32 s54, 86080
  buffer_load_dword v223, v228, s[4:7], s54 offen sc1
  s_mov_b32 s54, 94272
  buffer_load_dword v224, v228, s[4:7], s54 offen sc1
ccmp_73:
  s_waitcnt vmcnt(0)
  s_mov_b64 s[56:57], 0
  v_cmp_ne_u32 vcc, s35, v221
  s_or_b64 s[56:57], s[56:57], vcc
  v_cmp_ne_u32 vcc, s35, v222
  s_or_b64 s[56:57], s[56:57], vcc
  v_cmp_ne_u32 vcc, s35, v223
  s_or_b64 s[56:57], s[56:57], vcc
  v_cmp_ne_u32 vcc, s35, v224
  s_or_b64 s[56:57], s[56:57], vcc
  s_cmp_eq_u64 s[56:57], 0
  s_cbranch_scc1 cdone_72
  s_add_u32 s55, s55, 1
  s_cmp_lt_u32 s55, 1048576
  s_cbranch_scc1 cpoll_71
cdone_72:
cchk_70:
  v_mfma_f32_32x32x16_bf16 v[112:127], v[36:39], v[52:55], v[112:127]
  v_exp_f32 v92, v92
  v_exp_f32 v93, v93
  v_exp_f32 v94, v94
  v_exp_f32 v95, v95
  v_cvt_pk_bf16_f32 v56, v88, v89
  v_cvt_pk_bf16_f32 v57, v90, v91
  v_cvt_pk_bf16_f32 v58, v92, v93
  v_cvt_pk_bf16_f32 v59, v94, v95
  s_waitcnt vmcnt(0)
  s_barrier
  s_setprio 1
  v_mfma_f32_32x32x16_bf16 v[80:95], v[28:31], v[60:63], 0
  v_exp_f32 v64, v64
  v_exp_f32 v65, v65
  v_exp_f32 v66, v66
  v_exp_f32 v67, v67
  v_mfma_f32_32x32x16_bf16 v[112:127], v[44:47], v[56:59], v[112:127]
  ds_read_b128 v[24:27], v20 offset:24576
  ds_read_b64 v[32:33], v21 offset:24576
  s_cmp_eq_u32 s42, 0
  s_cbranch_scc0 P2_nodma_74
  s_add_u32 m0, s39, 49152
  s_nop 0
  buffer_load_dwordx4 v128, s[4:7], s38 offen sc1 lds
  buffer_load_dwordx4 v128, s[4:7], s38 offen offset:1024 sc1 lds
  s_mov_b64 exec, 0xffffffff
  buffer_load_dwordx4 v128, s[4:7], s38 offen offset:2048 sc1 lds
  s_mov_b64 exec, -1
  s_add_u32 s38, s38, 10240
P2_nodma_74:
  v_exp_f32 v68, v68
  v_exp_f32 v69, v69
  v_exp_f32 v70, v70
  v_exp_f32 v71, v71
  v_cvt_pk_bf16_f32 v52, v64, v65
  v_cvt_pk_bf16_f32 v53, v66, v67
  v_mfma_f32_32x32x8_bf16 v[80:95], v[34:35], v[18:19], v[80:95]
  v_cvt_pk_bf16_f32 v54, v68, v69
  v_cvt_pk_bf16_f32 v55, v70, v71
  v_exp_f32 v72, v72
  v_exp_f32 v73, v73
  v_exp_f32 v74, v74
  v_exp_f32 v75, v75
  s_waitcnt lgkmcnt(2)
  v_mfma_f32_32x32x16_bf16 v[96:111], v[40:43], v[52:55], v[96:111]
  v_exp_f32 v76, v76
  v_exp_f32 v77, v77
  v_exp_f32 v78, v78
  v_exp_f32 v79, v79
  v_cvt_pk_bf16_f32 v56, v72, v73
  v_cvt_pk_bf16_f32 v57, v74, v75
  v_cvt_pk_bf16_f32 v58, v76, v77
  v_cvt_pk_bf16_f32 v59, v78, v79
  s_setprio 0
  s_waitcnt lgkmcnt(0)
  v_mfma_f32_32x32x16_bf16 v[64:79], v[24:27], v[12:15], 0
  v_exp_f32 v80, v80
  v_exp_f32 v81, v81
  v_exp_f32 v82, v82
  v_exp_f32 v83, v83
  v_mfma_f32_32x32x16_bf16 v[96:111], v[48:51], v[56:59], v[96:111]
  ds_read_b128 v[36:39], v22 offset:24576
  ds_read_b128 v[44:47], v23 offset:24576
  s_cmp_eq_u32 s42, 1
  s_cbranch_scc0 P2_nodma_75
  s_add_u32 m0, s39, 49152
  s_nop 0
  buffer_load_dwordx4 v128, s[4:7], s38 offen sc1 lds
  buffer_load_dwordx4 v128, s[4:7], s38 offen offset:1024 sc1 lds
  s_mov_b64 exec, 0xffffffff
  buffer_load_dwordx4 v128, s[4:7], s38 offen offset:2048 sc1 lds
  s_mov_b64 exec, -1
  s_add_u32 s38, s38, 10240
P2_nodma_75:
  v_exp_f32 v84, v84
  v_exp_f32 v85, v85
  v_exp_f32 v86, v86
  v_exp_f32 v87, v87
  v_cvt_pk_bf16_f32 v52, v80, v81
  v_cvt_pk_bf16_f32 v53, v82, v83
  v_mfma_f32_32x32x8_bf16 v[64:79], v[32:33], v[16:17], v[64:79]
  v_cvt_pk_bf16_f32 v54, v84, v85
  v_cvt_pk_bf16_f32 v55, v86, v87
  v_exp_f32 v88, v88
  v_exp_f32 v89, v89
  v_exp_f32 v90, v90
  v_exp_f32 v91, v91
  v_mfma_f32_32x32x16_bf16 v[112:127], v[40:43], v[52:55], v[112:127]
  v_exp_f32 v92, v92
  v_exp_f32 v93, v93
  v_exp_f32 v94, v94
  v_exp_f32 v95, v95
  v_cvt_pk_bf16_f32 v56, v88, v89
  v_cvt_pk_bf16_f32 v57, v90, v91
  v_cvt_pk_bf16_f32 v58, v92, v93
  v_cvt_pk_bf16_f32 v59, v94, v95
  s_setprio 1
  v_mfma_f32_32x32x16_bf16 v[80:95], v[24:27], v[60:63], 0
  v_exp_f32 v64, v64
  v_exp_f32 v65, v65
  v_exp_f32 v66, v66
  v_exp_f32 v67, v67
  v_mfma_f32_32x32x16_bf16 v[112:127], v[48:51], v[56:59], v[112:127]
  ds_read_b128 v[28:31], v20 offset:27648
  ds_read_b64 v[34:35], v21 offset:27648
  v_exp_f32 v68, v68
  v_exp_f32 v69, v69
  v_exp_f32 v70, v70
  v_exp_f32 v71, v71
  v_cvt_pk_bf16_f32 v52, v64, v65
  v_cvt_pk_bf16_f32 v53, v66, v67
  v_mfma_f32_32x32x8_bf16 v[80:95], v[32:33], v[18:19], v[80:95]
  v_cvt_pk_bf16_f32 v54, v68, v69
  v_cvt_pk_bf16_f32 v55, v70, v71
  v_exp_f32 v72, v72
  v_exp_f32 v73, v73
  v_exp_f32 v74, v74
  v_exp_f32 v75, v75
  s_waitcnt lgkmcnt(2)
  buffer_load_dwordx4 v[132:135], v128, s[4:7], s64 offen sc1
  s_add_u32 s64, s64, 1024
  v_mfma_f32_32x32x16_bf16 v[96:111], v[36:39], v[52:55], v[96:111]
  v_exp_f32 v76, v76
  v_exp_f32 v77, v77
  v_exp_f32 v78, v78
  v_exp_f32 v79, v79
  v_cvt_pk_bf16_f32 v56, v72, v73
  v_cvt_pk_bf16_f32 v57, v74, v75
  v_cvt_pk_bf16_f32 v58, v76, v77
  v_cvt_pk_bf16_f32 v59, v78, v79
  s_setprio 0
  s_waitcnt lgkmcnt(0)
  v_mfma_f32_32x32x16_bf16 v[64:79], v[28:31], v[12:15], 0
  v_exp_f32 v80, v80
  v_exp_f32 v81, v81
  v_exp_f32 v82, v82
  v_exp_f32 v83, v83
  v_mfma_f32_32x32x16_bf16 v[96:111], v[44:47], v[56:59], v[96:111]
  ds_read_b128 v[40:43], v22 offset:27648
  ds_read_b128 v[48:51], v23 offset:27648
  v_exp_f32 v84, v84
  v_exp_f32 v85, v85
  v_exp_f32 v86, v86
  v_exp_f32 v87, v87
  v_cvt_pk_bf16_f32 v52, v80, v81
  v_cvt_pk_bf16_f32 v53, v82, v83
  v_mfma_f32_32x32x8_bf16 v[64:79], v[34:35], v[16:17], v[64:79]
  v_cvt_pk_bf16_f32 v54, v84, v85
  v_cvt_pk_bf16_f32 v55, v86, v87
  v_exp_f32 v88, v88
  v_exp_f32 v89, v89
  v_exp_f32 v90, v90
  v_exp_f32 v91, v91
  buffer_load_dwordx4 v[136:139], v128, s[4:7], s64 offen sc1
  s_add_u32 s64, s64, 1024
  s_lshl_b32 s54, s32, 10
  s_add_u32 m0, s54, 73728
  s_add_u32 s54, s54, 12288
  s_add_u32 s54, s54, s65
  buffer_load_dwordx4 v128, s[4:7], s54 offen sc1 lds
  v_mfma_f32_32x32x16_bf16 v[112:127], v[36:39], v[52:55], v[112:127]
  v_exp_f32 v92, v92
  v_exp_f32 v93, v93
  v_exp_f32 v94, v94
  v_exp_f32 v95, v95
  v_cvt_pk_bf16_f32 v56, v88, v89
  v_cvt_pk_bf16_f32 v57, v90, v91
  v_cvt_pk_bf16_f32 v58, v92, v93
  v_cvt_pk_bf16_f32 v59, v94, v95
  s_setprio 1
  v_mfma_f32_32x32x16_bf16 v[80:95], v[28:31], v[60:63], 0
  v_exp_f32 v64, v64
  v_exp_f32 v65, v65
  v_exp_f32 v66, v66
  v_exp_f32 v67, v67
  v_mfma_f32_32x32x16_bf16 v[112:127], v[44:47], v[56:59], v[112:127]
  ds_read_b128 v[24:27], v20 offset:30720
  ds_read_b64 v[32:33], v21 offset:30720
  v_exp_f32 v68, v68
  v_exp_f32 v69, v69
  v_exp_f32 v70, v70
  v_exp_f32 v71, v71
  v_cvt_pk_bf16_f32 v52, v64, v65
  v_cvt_pk_bf16_f32 v53, v66, v67
  v_mfma_f32_32x32x8_bf16 v[80:95], v[34:35], v[18:19], v[80:95]
  v_cvt_pk_bf16_f32 v54, v68, v69
  v_cvt_pk_bf16_f32 v55, v70, v71
  v_exp_f32 v72, v72
  v_exp_f32 v73, v73
  v_exp_f32 v74, v74
  v_exp_f32 v75, v75
  s_waitcnt lgkmcnt(2)
  buffer_load_dwordx4 v[140:143], v128, s[4:7], s64 offen sc1
  s_add_u32 s64, s64, 1024
  v_mfma_f32_32x32x16_bf16 v[96:111], v[40:43], v[52:55], v[96:111]
  v_exp_f32 v76, v76
  v_exp_f32 v77, v77
  v_exp_f32 v78, v78
  v_exp_f32 v79, v79
  v_cvt_pk_bf16_f32 v56, v72, v73
  v_cvt_pk_bf16_f32 v57, v74, v75
  v_cvt_pk_bf16_f32 v58, v76, v77
  v_cvt_pk_bf16_f32 v59, v78, v79
  s_setprio 0
  s_waitcnt lgkmcnt(0)
  v_mfma_f32_32x32x16_bf16 v[64:79], v[24:27], v[12:15], 0
  v_exp_f32 v80, v80
  v_exp_f32 v81, v81
  v_exp_f32 v82, v82
  v_exp_f32 v83, v83
  v_mfma_f32_32x32x16_bf16 v[96:111], v[48:51], v[56:59], v[96:111]
  ds_read_b128 v[36:39], v22 offset:30720
  ds_read_b128 v[44:47], v23 offset:30720
  v_exp_f32 v84, v84
  v_exp_f32 v85, v85
  v_exp_f32 v86, v86
  v_exp_f32 v87, v87
  v_cvt_pk_bf16_f32 v52, v80, v81
  v_cvt_pk_bf16_f32 v53, v82, v83
  v_mfma_f32_32x32x8_bf16 v[64:79], v[32:33], v[16:17], v[64:79]
  v_cvt_pk_bf16_f32 v54, v84, v85
  v_cvt_pk_bf16_f32 v55, v86, v87
  v_exp_f32 v88, v88
  v_exp_f32 v89, v89
  v_exp_f32 v90, v90
  v_exp_f32 v91, v91
  buffer_load_dwordx4 v[144:147], v128, s[4:7], s64 offen sc1
  s_add_u32 s64, s64, 1024
  s_lshl_b32 s54, s32, 10
  s_add_u32 m0, s54, 81920
  s_add_u32 s54, s54, 20480
  s_add_u32 s54, s54, s65
  buffer_load_dwordx4 v128, s[4:7], s54 offen sc1 lds
  v_mfma_f32_32x32x16_bf16 v[112:127], v[40:43], v[52:55], v[112:127]
  v_exp_f32 v92, v92
  v_exp_f32 v93, v93
  v_exp_f32 v94, v94
  v_exp_f32 v95, v95
  v_cvt_pk_bf16_f32 v56, v88, v89
  v_cvt_pk_bf16_f32 v57, v90, v91
  v_cvt_pk_bf16_f32 v58, v92, v93
  v_cvt_pk_bf16_f32 v59, v94, v95
  s_setprio 1
  v_mfma_f32_32x32x16_bf16 v[80:95], v[24:27], v[60:63], 0
  v_exp_f32 v64, v64
  v_exp_f32 v65, v65
  v_exp_f32 v66, v66
  v_exp_f32 v67, v67
  v_mfma_f32_32x32x16_bf16 v[112:127], v[48:51], v[56:59], v[112:127]
  ds_read_b128 v[28:31], v20 offset:33792
  ds_read_b64 v[34:35], v21 offset:33792
  v_exp_f32 v68, v68
  v_exp_f32 v69, v69
  v_exp_f32 v70, v70
  v_exp_f32 v71, v71
  v_cvt_pk_bf16_f32 v52, v64, v65
  v_cvt_pk_bf16_f32 v53, v66, v67
  v_mfma_f32_32x32x8_bf16 v[80:95], v[32:33], v[18:19], v[80:95]
  v_cvt_pk_bf16_f32 v54, v68, v69
  v_cvt_pk_bf16_f32 v55, v70, v71
  v_exp_f32 v72, v72
  v_exp_f32 v73, v73
  v_exp_f32 v74, v74
  v_exp_f32 v75, v75
  s_waitcnt lgkmcnt(2)
  buffer_load_dwordx4 v[148:151], v128, s[4:7], s64 offen sc1
  s_add_u32 s64, s64, 1024
  v_mfma_f32_32x32x16_bf16 v[96:111], v[36:39], v[52:55], v[96:111]
  v_exp_f32 v76, v76
  v_exp_f32 v77, v77
  v_exp_f32 v78, v78
  v_exp_f32 v79, v79
  v_cvt_pk_bf16_f32 v56, v72, v73
  v_cvt_pk_bf16_f32 v57, v74, v75
  v_cvt_pk_bf16_f32 v58, v76, v77
  v_cvt_pk_bf16_f32 v59, v78, v79
  s_setprio 0
  s_waitcnt lgkmcnt(0)
  v_mfma_f32_32x32x16_bf16 v[64:79], v[28:31], v[12:15], 0
  v_exp_f32 v80, v80
  v_exp_f32 v81, v81
  v_exp_f32 v82, v82
  v_exp_f32 v83, v83
  v_mfma_f32_32x32x16_bf16 v[96:111], v[44:47], v[56:59], v[96:111]
  ds_read_b128 v[40:43], v22 offset:33792
  ds_read_b128 v[48:51], v23 offset:33792
  v_exp_f32 v84, v84
  v_exp_f32 v85, v85
  v_exp_f32 v86, v86
  v_exp_f32 v87, v87
  v_cvt_pk_bf16_f32 v52, v80, v81
  v_cvt_pk_bf16_f32 v53, v82, v83
  v_mfma_f32_32x32x8_bf16 v[64:79], v[34:35], v[16:17], v[64:79]
  v_cvt_pk_bf16_f32 v54, v84, v85
  v_cvt_pk_bf16_f32 v55, v86, v87
  v_exp_f32 v88, v88
  v_exp_f32 v89, v89
  v_exp_f32 v90, v90
  v_exp_f32 v91, v91
  buffer_load_dwordx4 v[152:155], v128, s[4:7], s64 offen sc1
  s_add_u32 s64, s64, 1024
  s_lshl_b32 s54, s32, 10
  s_add_u32 m0, s54, 90112
  s_add_u32 s54, s54, 28672
  s_add_u32 s54, s54, s65
  buffer_load_dwordx4 v128, s[4:7], s54 offen sc1 lds
  v_mfma_f32_32x32x16_bf16 v[112:127], v[36:39], v[52:55], v[112:127]
  v_exp_f32 v92, v92
  v_exp_f32 v93, v93
  v_exp_f32 v94, v94
  v_exp_f32 v95, v95
  v_cvt_pk_bf16_f32 v56, v88, v89
  v_cvt_pk_bf16_f32 v57, v90, v91
  v_cvt_pk_bf16_f32 v58, v92, v93
  v_cvt_pk_bf16_f32 v59, v94, v95
  s_waitcnt vmcnt(9)
  s_barrier
  s_setprio 1
  v_mfma_f32_32x32x16_bf16 v[80:95], v[28:31], v[60:63], 0
  v_exp_f32 v64, v64
  v_exp_f32 v65, v65
  v_exp_f32 v66, v66
  v_exp_f32 v67, v67
  v_mfma_f32_32x32x16_bf16 v[112:127], v[44:47], v[56:59], v[112:127]
  ds_read_b128 v[24:27], v20 offset:49152
  ds_read_b64 v[32:33], v21 offset:49152
  s_cmp_eq_u32 s42, 0
  s_cbranch_scc0 P2_nodma_76
  s_add_u32 m0, s39, 0
  s_nop 0
  buffer_load_dwordx4 v128, s[4:7], s38 offen sc1 lds
  buffer_load_dwordx4 v128, s[4:7], s38 offen offset:1024 sc1 lds
  s_mov_b64 exec, 0xffffffff
  buffer_load_dwordx4 v128, s[4:7], s38 offen offset:2048 sc1 lds
  s_mov_b64 exec, -1
  s_add_u32 s38, s38, 10240
P2_nodma_76:
  v_exp_f32 v68, v68
  v_exp_f32 v69, v69
  v_exp_f32 v70, v70
  v_exp_f32 v71, v71
  v_cvt_pk_bf16_f32 v52, v64, v65
  v_cvt_pk_bf16_f32 v53, v66, v67
  v_mfma_f32_32x32x8_bf16 v[80:95], v[34:35], v[18:19], v[80:95]
  v_cvt_pk_bf16_f32 v54, v68, v69
  v_cvt_pk_bf16_f32 v55, v70, v71
  v_exp_f32 v72, v72
  v_exp_f32 v73, v73
  v_exp_f32 v74, v74
  v_exp_f32 v75, v75
  s_waitcnt lgkmcnt(2)
  buffer_load_dwordx4 v[156:159], v128, s[4:7], s64 offen sc1
  s_add_u32 s64, s64, 1024
  v_mfma_f32_32x32x16_bf16 v[96:111], v[40:43], v[52:55], v[96:111]
  v_exp_f32 v76, v76
  v_exp_f32 v77, v77
  v_exp_f32 v78, v78
  v_exp_f32 v79, v79
  v_cvt_pk_bf16_f32 v56, v72, v73
  v_cvt_pk_bf16_f32 v57, v74, v75
  v_cvt_pk_bf16_f32 v58, v76, v77
  v_cvt_pk_bf16_f32 v59, v78, v79
  s_setprio 0
  s_waitcnt lgkmcnt(0)
  v_mfma_f32_32x32x16_bf16 v[64:79], v[24:27], v[12:15], 0
  v_exp_f32 v80, v80
  v_exp_f32 v81, v81
  v_exp_f32 v82, v82
  v_exp_f32 v83, v83
  v_mfma_f32_32x32x16_bf16 v[96:111], v[48:51], v[56:59], v[96:111]
  ds_read_b128 v[36:39], v22 offset:49152
  ds_read_b128 v[44:47], v23 offset:49152
  s_cmp_eq_u32 s42, 1
  s_cbranch_scc0 P2_nodma_77
  s_add_u32 m0, s39, 0
  s_nop 0
  buffer_load_dwordx4 v128, s[4:7], s38 offen sc1 lds
  buffer_load_dwordx4 v128, s[4:7], s38 offen offset:1024 sc1 lds
  s_mov_b64 exec, 0xffffffff
  buffer_load_dwordx4 v128, s[4:7], s38 offen offset:2048 sc1 lds
  s_mov_b64 exec, -1
  s_add_u32 s38, s38, 10240
P2_nodma_77:
  v_exp_f32 v84, v84
  v_exp_f32 v85, v85
  v_exp_f32 v86, v86
  v_exp_f32 v87, v87
  v_cvt_pk_bf16_f32 v52, v80, v81
  v_cvt_pk_bf16_f32 v53, v82, v83
  v_mfma_f32_32x32x8_bf16 v[64:79], v[32:33], v[16:17], v[64:79]
  v_cvt_pk_bf16_f32 v54, v84, v85
  v_cvt_pk_bf16_f32 v55, v86, v87
  v_exp_f32 v88, v88
  v_exp_f32 v89, v89
  v_exp_f32 v90, v90
  v_exp_f32 v91, v91
  buffer_load_dwordx4 v[160:163], v128, s[4:7], s64 offen sc1
  s_add_u32 s64, s64, 1024
  s_lshl_b32 s54, s32, 10
  s_add_u32 m0, s54, 98304
  s_add_u32 s54, s54, 36864
  s_add_u32 s54, s54, s65
  buffer_load_dwordx4 v128, s[4:7], s54 offen sc1 lds
  v_mfma_f32_32x32x16_bf16 v[112:127], v[40:43], v[52:55], v[112:127]
  v_exp_f32 v92, v92
  v_exp_f32 v93, v93
  v_exp_f32 v94, v94
  v_exp_f32 v95, v95
  v_cvt_pk_bf16_f32 v56, v88, v89
  v_cvt_pk_bf16_f32 v57, v90, v91
  v_cvt_pk_bf16_f32 v58, v92, v93
  v_cvt_pk_bf16_f32 v59, v94, v95
  s_setprio 1
  v_mfma_f32_32x32x16_bf16 v[80:95], v[24:27], v[60:63], 0
  v_exp_f32 v64, v64
  v_exp_f32 v65, v65
  v_exp_f32 v66, v66
  v_exp_f32 v67, v67
  v_mfma_f32_32x32x16_bf16 v[112:127], v[48:51], v[56:59], v[112:127]
  ds_read_b128 v[28:31], v20 offset:52224
  ds_read_b64 v[34:35], v21 offset:52224
  v_exp_f32 v68, v68
  v_exp_f32 v69, v69
  v_exp_f32 v70, v70
  v_exp_f32 v71, v71
  v_cvt_pk_bf16_f32 v52, v64, v65
  v_cvt_pk_bf16_f32 v53, v66, v67
  v_mfma_f32_32x32x8_bf16 v[80:95], v[32:33], v[18:19], v[80:95]
  v_cvt_pk_bf16_f32 v54, v68, v69
  v_cvt_pk_bf16_f32 v55, v70, v71
  v_exp_f32 v72, v72
  v_exp_f32 v73, v73
  v_exp_f32 v74, v74
  v_exp_f32 v75, v75
  s_waitcnt lgkmcnt(2)
  buffer_load_dwordx4 v[164:167], v128, s[4:7], s64 offen sc1
  s_add_u32 s64, s64, 1024
  v_mfma_f32_32x32x16_bf16 v[96:111], v[36:39], v[52:55], v[96:111]
  v_exp_f32 v76, v76
  v_exp_f32 v77, v77
  v_exp_f32 v78, v78
  v_exp_f32 v79, v79
  v_cvt_pk_bf16_f32 v56, v72, v73
  v_cvt_pk_bf16_f32 v57, v74, v75
  v_cvt_pk_bf16_f32 v58, v76, v77
  v_cvt_pk_bf16_f32 v59, v78, v79
  s_setprio 0
  s_waitcnt lgkmcnt(0)
  v_mfma_f32_32x32x16_bf16 v[64:79], v[28:31], v[12:15], 0
  v_exp_f32 v80, v80
  v_exp_f32 v81, v81
  v_exp_f32 v82, v82
  v_exp_f32 v83, v83
  v_mfma_f32_32x32x16_bf16 v[96:111], v[44:47], v[56:59], v[96:111]
  ds_read_b128 v[40:43], v22 offset:52224
  ds_read_b128 v[48:51], v23 offset:52224
  v_exp_f32 v84, v84
  v_exp_f32 v85, v85
  v_exp_f32 v86, v86
  v_exp_f32 v87, v87
  v_cvt_pk_bf16_f32 v52, v80, v81
  v_cvt_pk_bf16_f32 v53, v82, v83
  v_mfma_f32_32x32x8_bf16 v[64:79], v[34:35], v[16:17], v[64:79]
  v_cvt_pk_bf16_f32 v54, v84, v85
  v_cvt_pk_bf16_f32 v55, v86, v87
  v_exp_f32 v88, v88
  v_exp_f32 v89, v89
  v_exp_f32 v90, v90
  v_exp_f32 v91, v91
  buffer_load_dwordx4 v[168:171], v128, s[4:7], s64 offen sc1
  s_add_u32 s64, s64, 1024
  s_lshl_b32 s54, s32, 10
  s_add_u32 m0, s54, 106496
  s_add_u32 s54, s54, 45056
  s_add_u32 s54, s54, s65
  buffer_load_dwordx4 v128, s[4:7], s54 offen sc1 lds
  v_mfma_f32_32x32x16_bf16 v[112:127], v[36:39], v[52:55], v[112:127]
  v_exp_f32 v92, v92
  v_exp_f32 v93, v93
  v_exp_f32 v94, v94
  v_exp_f32 v95, v95
  v_cvt_pk_bf16_f32 v56, v88, v89
  v_cvt_pk_bf16_f32 v57, v90, v91
  v_cvt_pk_bf16_f32 v58, v92, v93
  v_cvt_pk_bf16_f32 v59, v94, v95
  s_setprio 1
  v_mfma_f32_32x32x16_bf16 v[80:95], v[28:31], v[60:63], 0
  v_exp_f32 v64, v64
  v_exp_f32 v65, v65
  v_exp_f32 v66, v66
  v_exp_f32 v67, v67
  v_mfma_f32_32x32x16_bf16 v[112:127], v[44:47], v[56:59], v[112:127]
  ds_read_b128 v[24:27], v20 offset:55296
  ds_read_b64 v[32:33], v21 offset:55296
  v_exp_f32 v68, v68
  v_exp_f32 v69, v69
  v_exp_f32 v70, v70
  v_exp_f32 v71, v71
  v_cvt_pk_bf16_f32 v52, v64, v65
  v_cvt_pk_bf16_f32 v53, v66, v67
  v_mfma_f32_32x32x8_bf16 v[80:95], v[34:35], v[18:19], v[80:95]
  v_cvt_pk_bf16_f32 v54, v68, v69
  v_cvt_pk_bf16_f32 v55, v70, v71
  v_exp_f32 v72, v72
  v_exp_f32 v73, v73
  v_exp_f32 v74, v74
  v_exp_f32 v75, v75
  s_waitcnt lgkmcnt(2)
  buffer_load_dwordx4 v[172:175], v128, s[4:7], s64 offen sc1
  s_add_u32 s64, s64, 1024
  v_mfma_f32_32x32x16_bf16 v[96:111], v[40:43], v[52:55], v[96:111]
  v_exp_f32 v76, v76
  v_exp_f32 v77, v77
  v_exp_f32 v78, v78
  v_exp_f32 v79, v79
  v_cvt_pk_bf16_f32 v56, v72, v73
  v_cvt_pk_bf16_f32 v57, v74, v75
  v_cvt_pk_bf16_f32 v58, v76, v77
  v_cvt_pk_bf16_f32 v59, v78, v79
  s_setprio 0
  s_waitcnt lgkmcnt(0)
  v_mfma_f32_32x32x16_bf16 v[64:79], v[24:27], v[12:15], 0
  v_exp_f32 v80, v80
  v_exp_f32 v81, v81
  v_exp_f32 v82, v82
  v_exp_f32 v83, v83
  v_mfma_f32_32x32x16_bf16 v[96:111], v[48:51], v[56:59], v[96:111]
  ds_read_b128 v[36:39], v22 offset:55296
  ds_read_b128 v[44:47], v23 offset:55296
  v_exp_f32 v84, v84
  v_exp_f32 v85, v85
  v_exp_f32 v86, v86
  v_exp_f32 v87, v87
  v_cvt_pk_bf16_f32 v52, v80, v81
  v_cvt_pk_bf16_f32 v53, v82, v83
  v_mfma_f32_32x32x8_bf16 v[64:79], v[32:33], v[16:17], v[64:79]
  v_cvt_pk_bf16_f32 v54, v84, v85
  v_cvt_pk_bf16_f32 v55, v86, v87
  v_exp_f32 v88, v88
  v_exp_f32 v89, v89
  v_exp_f32 v90, v90
  v_exp_f32 v91, v91
  buffer_load_dwordx4 v[176:179], v128, s[4:7], s64 offen sc1
  s_add_u32 s64, s64, 1024
  s_lshl_b32 s54, s32, 10
  s_add_u32 m0, s54, 114688
  s_add_u32 s54, s54, 53248
  s_add_u32 s54, s54, s65
  buffer_load_dwordx4 v128, s[4:7], s54 offen sc1 lds
  v_mfma_f32_32x32x16_bf16 v[112:127], v[40:43], v[52:55], v[112:127]
  v_exp_f32 v92, v92
  v_exp_f32 v93, v93
  v_exp_f32 v94, v94
  v_exp_f32 v95, v95
  v_cvt_pk_bf16_f32 v56, v88, v89
  v_cvt_pk_bf16_f32 v57, v90, v91
  v_cvt_pk_bf16_f32 v58, v92, v93
  v_cvt_pk_bf16_f32 v59, v94, v95
  s_setprio 1
  v_mfma_f32_32x32x16_bf16 v[80:95], v[24:27], v[60:63], 0
  v_exp_f32 v64, v64
  v_exp_f32 v65, v65
  v_exp_f32 v66, v66
  v_exp_f32 v67, v67
  v_mfma_f32_32x32x16_bf16 v[112:127], v[48:51], v[56:59], v[112:127]
  ds_read_b128 v[28:31], v20 offset:58368
  ds_read_b64 v[34:35], v21 offset:58368
  v_exp_f32 v68, v68
  v_exp_f32 v69, v69
  v_exp_f32 v70, v70
  v_exp_f32 v71, v71
  v_cvt_pk_bf16_f32 v52, v64, v65
  v_cvt_pk_bf16_f32 v53, v66, v67
  v_mfma_f32_32x32x8_bf16 v[80:95], v[32:33], v[18:19], v[80:95]
  v_cvt_pk_bf16_f32 v54, v68, v69
  v_cvt_pk_bf16_f32 v55, v70, v71
  v_exp_f32 v72, v72
  v_exp_f32 v73, v73
  v_exp_f32 v74, v74
  v_exp_f32 v75, v75
  s_waitcnt lgkmcnt(2)
  buffer_load_dwordx4 v[180:183], v128, s[4:7], s64 offen sc1
  s_add_u32 s64, s64, 1024
  v_mfma_f32_32x32x16_bf16 v[96:111], v[36:39], v[52:55], v[96:111]
  v_exp_f32 v76, v76
  v_exp_f32 v77, v77
  v_exp_f32 v78, v78
  v_exp_f32 v79, v79
  v_cvt_pk_bf16_f32 v56, v72, v73
  v_cvt_pk_bf16_f32 v57, v74, v75
  v_cvt_pk_bf16_f32 v58, v76, v77
  v_cvt_pk_bf16_f32 v59, v78, v79
  s_setprio 0
  s_waitcnt lgkmcnt(0)
  v_mfma_f32_32x32x16_bf16 v[64:79], v[28:31], v[12:15], 0
  v_exp_f32 v80, v80
  v_exp_f32 v81, v81
  v_exp_f32 v82, v82
  v_exp_f32 v83, v83
  v_mfma_f32_32x32x16_bf16 v[96:111], v[44:47], v[56:59], v[96:111]
  ds_read_b128 v[40:43], v22 offset:58368
  ds_read_b128 v[48:51], v23 offset:58368
  v_exp_f32 v84, v84
  v_exp_f32 v85, v85
  v_exp_f32 v86, v86
  v_exp_f32 v87, v87
  v_cvt_pk_bf16_f32 v52, v80, v81
  v_cvt_pk_bf16_f32 v53, v82, v83
  v_mfma_f32_32x32x8_bf16 v[64:79], v[34:35], v[16:17], v[64:79]
  v_cvt_pk_bf16_f32 v54, v84, v85
  v_cvt_pk_bf16_f32 v55, v86, v87
  v_exp_f32 v88, v88
  v_exp_f32 v89, v89
  v_exp_f32 v90, v90
  v_exp_f32 v91, v91
  buffer_load_dwordx4 v[184:187], v128, s[4:7], s64 offen sc1
  s_add_u32 s64, s64, 1024
  s_lshl_b32 s54, s32, 10
  s_add_u32 m0, s54, 122880
  s_add_u32 s54, s54, 61440
  s_add_u32 s54, s54, s65
  buffer_load_dwordx4 v128, s[4:7], s54 offen sc1 lds
  v_mfma_f32_32x32x16_bf16 v[112:127], v[36:39], v[52:55], v[112:127]
  v_exp_f32 v92, v92
  v_exp_f32 v93, v93
  v_exp_f32 v94, v94
  v_exp_f32 v95, v95
  v_cvt_pk_bf16_f32 v56, v88, v89
  v_cvt_pk_bf16_f32 v57, v90, v91
  v_cvt_pk_bf16_f32 v58, v92, v93
  v_cvt_pk_bf16_f32 v59, v94, v95
  s_waitcnt vmcnt(9)
  s_barrier
  s_setprio 1
  v_mfma_f32_32x32x16_bf16 v[80:95], v[28:31], v[60:63], 0
  v_exp_f32 v64, v64
  v_exp_f32 v65, v65
  v_exp_f32 v66, v66
  v_exp_f32 v67, v67
  v_mfma_f32_32x32x16_bf16 v[112:127], v[44:47], v[56:59], v[112:127]
  ds_read_b128 v[24:27], v20 offset:0
  ds_read_b64 v[32:33], v21 offset:0
  s_cmp_eq_u32 s42, 0
  s_cbranch_scc0 P2_nodma_78
  s_add_u32 m0, s39, 24576
  s_nop 0
  buffer_load_dwordx4 v128, s[4:7], s38 offen sc1 lds
  buffer_load_dwordx4 v128, s[4:7], s38 offen offset:1024 sc1 lds
  s_mov_b64 exec, 0xffffffff
  buffer_load_dwordx4 v128, s[4:7], s38 offen offset:2048 sc1 lds
  s_mov_b64 exec, -1
  s_add_u32 s38, s38, 10240
P2_nodma_78:
  v_exp_f32 v68, v68
  v_exp_f32 v69, v69
  v_exp_f32 v70, v70
  v_exp_f32 v71, v71
  v_cvt_pk_bf16_f32 v52, v64, v65
  v_cvt_pk_bf16_f32 v53, v66, v67
  v_mfma_f32_32x32x8_bf16 v[80:95], v[34:35], v[18:19], v[80:95]
  v_cvt_pk_bf16_f32 v54, v68, v69
  v_cvt_pk_bf16_f32 v55, v70, v71
  v_exp_f32 v72, v72
  v_exp_f32 v73, v73
  v_exp_f32 v74, v74
  v_exp_f32 v75, v75
  s_waitcnt lgkmcnt(2)
  buffer_load_dwordx4 v[188:191], v128, s[4:7], s64 offen sc1
  s_add_u32 s64, s64, 1024
  v_mfma_f32_32x32x16_bf16 v[96:111], v[40:43], v[52:55], v[96:111]
  v_exp_f32 v76, v76
  v_exp_f32 v77, v77
  v_exp_f32 v78, v78
  v_exp_f32 v79, v79
  v_cvt_pk_bf16_f32 v56, v72, v73
  v_cvt_pk_bf16_f32 v57, v74, v75
  v_cvt_pk_bf16_f32 v58, v76, v77
  v_cvt_pk_bf16_f32 v59, v78, v79
  s_setprio 0
  s_waitcnt lgkmcnt(0)
  v_mfma_f32_32x32x16_bf16 v[64:79], v[24:27], v[12:15], 0
  v_exp_f32 v80, v80
  v_exp_f32 v81, v81
  v_exp_f32 v82, v82
  v_exp_f32 v83, v83
  v_mfma_f32_32x32x16_bf16 v[96:111], v[48:51], v[56:59], v[96:111]
  ds_read_b128 v[36:39], v22 offset:0
  ds_read_b128 v[44:47], v23 offset:0
  s_cmp_eq_u32 s42, 1
  s_cbranch_scc0 P2_nodma_79
  s_add_u32 m0, s39, 24576
  s_nop 0
  buffer_load_dwordx4 v128, s[4:7], s38 offen sc1 lds
  buffer_load_dwordx4 v128, s[4:7], s38 offen offset:1024 sc1 lds
  s_mov_b64 exec, 0xffffffff
  buffer_load_dwordx4 v128, s[4:7], s38 offen offset:2048 sc1 lds
  s_mov_b64 exec, -1
  s_add_u32 s38, s38, 10240
P2_nodma_79:
  v_exp_f32 v84, v84
  v_exp_f32 v85, v85
  v_exp_f32 v86, v86
  v_exp_f32 v87, v87
  v_cvt_pk_bf16_f32 v52, v80, v81
  v_cvt_pk_bf16_f32 v53, v82, v83
  v_mfma_f32_32x32x8_bf16 v[64:79], v[32:33], v[16:17], v[64:79]
  v_cvt_pk_bf16_f32 v54, v84, v85
  v_cvt_pk_bf16_f32 v55, v86, v87
  v_exp_f32 v88, v88
  v_exp_f32 v89, v89
  v_exp_f32 v90, v90
  v_exp_f32 v91, v91
  buffer_load_dwordx4 v[192:195], v128, s[4:7], s64 offen sc1
  s_add_u32 s64, s64, 1024
  s_lshl_b32 s54, s32, 10
  s_add_u32 m0, s54, 131072
  s_add_u32 s54, s54, 69632
  s_add_u32 s54, s54, s65
  buffer_load_dwordx4 v128, s[4:7], s54 offen sc1 lds
  v_mfma_f32_32x32x16_bf16 v[112:127], v[40:43], v[52:55], v[112:127]
  v_exp_f32 v92, v92
  v_exp_f32 v93, v93
  v_exp_f32 v94, v94
  v_exp_f32 v95, v95
  v_cvt_pk_bf16_f32 v56, v88, v89
  v_cvt_pk_bf16_f32 v57, v90, v91
  v_cvt_pk_bf16_f32 v58, v92, v93
  v_cvt_pk_bf16_f32 v59, v94, v95
  s_setprio 1
  v_mfma_f32_32x32x16_bf16 v[80:95], v[24:27], v[60:63], 0
  v_exp_f32 v64, v64
  v_exp_f32 v65, v65
  v_exp_f32 v66, v66
  v_exp_f32 v67, v67
  v_mfma_f32_32x32x16_bf16 v[112:127], v[48:51], v[56:59], v[112:127]
  ds_read_b128 v[28:31], v20 offset:3072
  ds_read_b64 v[34:35], v21 offset:3072
  v_exp_f32 v68, v68
  v_exp_f32 v69, v69
  v_exp_f32 v70, v70
  v_exp_f32 v71, v71
  v_cvt_pk_bf16_f32 v52, v64, v65
  v_cvt_pk_bf16_f32 v53, v66, v67
  v_mfma_f32_32x32x8_bf16 v[80:95], v[32:33], v[18:19], v[80:95]
  v_cvt_pk_bf16_f32 v54, v68, v69
  v_cvt_pk_bf16_f32 v55, v70, v71
  v_exp_f32 v72, v72
  v_exp_f32 v73, v73
  v_exp_f32 v74, v74
  v_exp_f32 v75, v75
  s_waitcnt lgkmcnt(2)
  buffer_load_dwordx4 v[196:199], v128, s[4:7], s64 offen sc1
  s_add_u32 s64, s64, 1024
  v_mfma_f32_32x32x16_bf16 v[96:111], v[36:39], v[52:55], v[96:111]
  v_exp_f32 v76, v76
  v_exp_f32 v77, v77
  v_exp_f32 v78, v78
  v_exp_f32 v79, v79
  v_cvt_pk_bf16_f32 v56, v72, v73
  v_cvt_pk_bf16_f32 v57, v74, v75
  v_cvt_pk_bf16_f32 v58, v76, v77
  v_cvt_pk_bf16_f32 v59, v78, v79
  s_setprio 0
  s_waitcnt lgkmcnt(0)
  v_mfma_f32_32x32x16_bf16 v[64:79], v[28:31], v[12:15], 0
  v_exp_f32 v80, v80
  v_exp_f32 v81, v81
  v_exp_f32 v82, v82
  v_exp_f32 v83, v83
  v_mfma_f32_32x32x16_bf16 v[96:111], v[44:47], v[56:59], v[96:111]
  ds_read_b128 v[40:43], v22 offset:3072
  ds_read_b128 v[48:51], v23 offset:3072
  v_exp_f32 v84, v84
  v_exp_f32 v85, v85
  v_exp_f32 v86, v86
  v_exp_f32 v87, v87
  v_cvt_pk_bf16_f32 v52, v80, v81
  v_cvt_pk_bf16_f32 v53, v82, v83
  v_mfma_f32_32x32x8_bf16 v[64:79], v[34:35], v[16:17], v[64:79]
  v_cvt_pk_bf16_f32 v54, v84, v85
  v_cvt_pk_bf16_f32 v55, v86, v87
  v_exp_f32 v88, v88
  v_exp_f32 v89, v89
  v_exp_f32 v90, v90
  v_exp_f32 v91, v91
  buffer_load_dwordx4 v[200:203], v128, s[4:7], s64 offen sc1
  s_add_u32 s64, s64, 1024
  s_lshl_b32 s54, s32, 10
  s_add_u32 m0, s54, 139264
  s_add_u32 s54, s54, 77824
  s_add_u32 s54, s54, s65
  buffer_load_dwordx4 v128, s[4:7], s54 offen sc1 lds
  v_mfma_f32_32x32x16_bf16 v[112:127], v[36:39], v[52:55], v[112:127]
  v_exp_f32 v92, v92
  v_exp_f32 v93, v93
  v_exp_f32 v94, v94
  v_exp_f32 v95, v95
  v_cvt_pk_bf16_f32 v56, v88, v89
  v_cvt_pk_bf16_f32 v57, v90, v91
  v_cvt_pk_bf16_f32 v58, v92, v93
  v_cvt_pk_bf16_f32 v59, v94, v95
  s_setprio 1
  v_mfma_f32_32x32x16_bf16 v[80:95], v[28:31], v[60:63], 0
  v_exp_f32 v64, v64
  v_exp_f32 v65, v65
  v_exp_f32 v66, v66
  v_exp_f32 v67, v67
  v_mfma_f32_32x32x16_bf16 v[112:127], v[44:47], v[56:59], v[112:127]
  ds_read_b128 v[24:27], v20 offset:6144
  ds_read_b64 v[32:33], v21 offset:6144
  v_exp_f32 v68, v68
  v_exp_f32 v69, v69
  v_exp_f32 v70, v70
  v_exp_f32 v71, v71
  v_cvt_pk_bf16_f32 v52, v64, v65
  v_cvt_pk_bf16_f32 v53, v66, v67
  v_mfma_f32_32x32x8_bf16 v[80:95], v[34:35], v[18:19], v[80:95]
  v_cvt_pk_bf16_f32 v54, v68, v69
  v_cvt_pk_bf16_f32 v55, v70, v71
  v_exp_f32 v72, v72
  v_exp_f32 v73, v73
  v_exp_f32 v74, v74
  v_exp_f32 v75, v75
  s_waitcnt lgkmcnt(2)
  buffer_load_dwordx4 v[204:207], v128, s[4:7], s64 offen sc1
  s_add_u32 s64, s64, 1024
  v_mfma_f32_32x32x16_bf16 v[96:111], v[40:43], v[52:55], v[96:111]
  v_exp_f32 v76, v76
  v_exp_f32 v77, v77
  v_exp_f32 v78, v78
  v_exp_f32 v79, v79
  v_cvt_pk_bf16_f32 v56, v72, v73
  v_cvt_pk_bf16_f32 v57, v74, v75
  v_cvt_pk_bf16_f32 v58, v76, v77
  v_cvt_pk_bf16_f32 v59, v78, v79
  s_setprio 0
  s_waitcnt lgkmcnt(0)
  v_mfma_f32_32x32x16_bf16 v[64:79], v[24:27], v[12:15], 0
  v_exp_f32 v80, v80
  v_exp_f32 v81, v81
  v_exp_f32 v82, v82
  v_exp_f32 v83, v83
  v_mfma_f32_32x32x16_bf16 v[96:111], v[48:51], v[56:59], v[96:111]
  ds_read_b128 v[36:39], v22 offset:6144
  ds_read_b128 v[44:47], v23 offset:6144
  v_exp_f32 v84, v84
  v_exp_f32 v85, v85
  v_exp_f32 v86, v86
  v_exp_f32 v87, v87
  v_cvt_pk_bf16_f32 v52, v80, v81
  v_cvt_pk_bf16_f32 v53, v82, v83
  v_mfma_f32_32x32x8_bf16 v[64:79], v[32:33], v[16:17], v[64:79]
  v_cvt_pk_bf16_f32 v54, v84, v85
  v_cvt_pk_bf16_f32 v55, v86, v87
  v_exp_f32 v88, v88
  v_exp_f32 v89, v89
  v_exp_f32 v90, v90
  v_exp_f32 v91, v91
  buffer_load_dwordx4 v[208:211], v128, s[4:7], s64 offen sc1
  s_add_u32 s64, s64, 1024
  s_lshl_b32 s54, s32, 10
  s_add_u32 m0, s54, 147456
  s_add_u32 s54, s54, 86016
  s_add_u32 s54, s54, s65
  buffer_load_dwordx4 v128, s[4:7], s54 offen sc1 lds
  v_mfma_f32_32x32x16_bf16 v[112:127], v[40:43], v[52:55], v[112:127]
  v_exp_f32 v92, v92
  v_exp_f32 v93, v93
  v_exp_f32 v94, v94
  v_exp_f32 v95, v95
  v_cvt_pk_bf16_f32 v56, v88, v89
  v_cvt_pk_bf16_f32 v57, v90, v91
  v_cvt_pk_bf16_f32 v58, v92, v93
  v_cvt_pk_bf16_f32 v59, v94, v95
  s_setprio 1
  v_mfma_f32_32x32x16_bf16 v[80:95], v[24:27], v[60:63], 0
  v_exp_f32 v64, v64
  v_exp_f32 v65, v65
  v_exp_f32 v66, v66
  v_exp_f32 v67, v67
  v_mfma_f32_32x32x16_bf16 v[112:127], v[48:51], v[56:59], v[112:127]
  ds_read_b128 v[28:31], v20 offset:9216
  ds_read_b64 v[34:35], v21 offset:9216
  v_exp_f32 v68, v68
  v_exp_f32 v69, v69
  v_exp_f32 v70, v70
  v_exp_f32 v71, v71
  v_cvt_pk_bf16_f32 v52, v64, v65
  v_cvt_pk_bf16_f32 v53, v66, v67
  v_mfma_f32_32x32x8_bf16 v[80:95], v[32:33], v[18:19], v[80:95]
  v_cvt_pk_bf16_f32 v54, v68, v69
  v_cvt_pk_bf16_f32 v55, v70, v71
  v_exp_f32 v72, v72
  v_exp_f32 v73, v73
  v_exp_f32 v74, v74
  v_exp_f32 v75, v75
  s_waitcnt lgkmcnt(2)
  buffer_load_dwordx4 v[212:215], v128, s[4:7], s64 offen sc1
  s_add_u32 s64, s64, 1024
  v_mfma_f32_32x32x16_bf16 v[96:111], v[36:39], v[52:55], v[96:111]
  v_exp_f32 v76, v76
  v_exp_f32 v77, v77
  v_exp_f32 v78, v78
  v_exp_f32 v79, v79
  v_cvt_pk_bf16_f32 v56, v72, v73
  v_cvt_pk_bf16_f32 v57, v74, v75
  v_cvt_pk_bf16_f32 v58, v76, v77
  v_cvt_pk_bf16_f32 v59, v78, v79
  s_setprio 0
  s_waitcnt lgkmcnt(0)
  v_mfma_f32_32x32x16_bf16 v[64:79], v[28:31], v[12:15], 0
  v_exp_f32 v80, v80
  v_exp_f32 v81, v81
  v_exp_f32 v82, v82
  v_exp_f32 v83, v83
  v_mfma_f32_32x32x16_bf16 v[96:111], v[44:47], v[56:59], v[96:111]
  ds_read_b128 v[40:43], v22 offset:9216
  ds_read_b128 v[48:51], v23 offset:9216
  v_exp_f32 v84, v84
  v_exp_f32 v85, v85
  v_exp_f32 v86, v86
  v_exp_f32 v87, v87
  v_cvt_pk_bf16_f32 v52, v80, v81
  v_cvt_pk_bf16_f32 v53, v82, v83
  v_mfma_f32_32x32x8_bf16 v[64:79], v[34:35], v[16:17], v[64:79]
  v_cvt_pk_bf16_f32 v54, v84, v85
  v_cvt_pk_bf16_f32 v55, v86, v87
  v_exp_f32 v88, v88
  v_exp_f32 v89, v89
  v_exp_f32 v90, v90
  v_exp_f32 v91, v91
  buffer_load_dwordx4 v[216:219], v128, s[4:7], s64 offen sc1
  s_add_u32 s64, s64, 1024
  s_lshl_b32 s54, s32, 10
  s_add_u32 m0, s54, 155648
  s_add_u32 s54, s54, 94208
  s_add_u32 s54, s54, s65
  buffer_load_dwordx4 v128, s[4:7], s54 offen sc1 lds
  v_mfma_f32_32x32x16_bf16 v[112:127], v[36:39], v[52:55], v[112:127]
  v_exp_f32 v92, v92
  v_exp_f32 v93, v93
  v_exp_f32 v94, v94
  v_exp_f32 v95, v95
  v_cvt_pk_bf16_f32 v56, v88, v89
  v_cvt_pk_bf16_f32 v57, v90, v91
  v_cvt_pk_bf16_f32 v58, v92, v93
  v_cvt_pk_bf16_f32 v59, v94, v95
  s_waitcnt vmcnt(9)
  s_barrier
  s_setprio 1
  v_mfma_f32_32x32x16_bf16 v[80:95], v[28:31], v[60:63], 0
  v_exp_f32 v64, v64
  v_exp_f32 v65, v65
  v_exp_f32 v66, v66
  v_exp_f32 v67, v67
  v_mfma_f32_32x32x16_bf16 v[112:127], v[44:47], v[56:59], v[112:127]
  ds_read_b128 v[24:27], v20 offset:24576
  ds_read_b64 v[32:33], v21 offset:24576
  v_exp_f32 v68, v68
  v_exp_f32 v69, v69
  v_exp_f32 v70, v70
  v_exp_f32 v71, v71
  v_cvt_pk_bf16_f32 v52, v64, v65
  v_cvt_pk_bf16_f32 v53, v66, v67
  v_mfma_f32_32x32x8_bf16 v[80:95], v[34:35], v[18:19], v[80:95]
  v_cvt_pk_bf16_f32 v54, v68, v69
  v_cvt_pk_bf16_f32 v55, v70, v71
  v_exp_f32 v72, v72
  v_exp_f32 v73, v73
  v_exp_f32 v74, v74
  v_exp_f32 v75, v75
  s_waitcnt lgkmcnt(2)
  buffer_load_dwordx4 v[220:223], v128, s[4:7], s64 offen sc1
  s_add_u32 s64, s64, 1024
  v_mfma_f32_32x32x16_bf16 v[96:111], v[40:43], v[52:55], v[96:111]
  v_exp_f32 v76, v76
  v_exp_f32 v77, v77
  v_exp_f32 v78, v78
  v_exp_f32 v79, v79
  v_cvt_pk_bf16_f32 v56, v72, v73
  v_cvt_pk_bf16_f32 v57, v74, v75
  v_cvt_pk_bf16_f32 v58, v76, v77
  v_cvt_pk_bf16_f32 v59, v78, v79
  s_setprio 0
  s_waitcnt lgkmcnt(0)
  v_mfma_f32_32x32x16_bf16 v[64:79], v[24:27], v[12:15], 0
  v_exp_f32 v80, v80
  v_exp_f32 v81, v81
  v_exp_f32 v82, v82
  v_exp_f32 v83, v83
  v_mfma_f32_32x32x16_bf16 v[96:111], v[48:51], v[56:59], v[96:111]
  ds_read_b128 v[36:39], v22 offset:24576
  ds_read_b128 v[44:47], v23 offset:24576
  v_exp_f32 v84, v84
  v_exp_f32 v85, v85
  v_exp_f32 v86, v86
  v_exp_f32 v87, v87
  v_cvt_pk_bf16_f32 v52, v80, v81
  v_cvt_pk_bf16_f32 v53, v82, v83
  v_mfma_f32_32x32x8_bf16 v[64:79], v[32:33], v[16:17], v[64:79]
  v_cvt_pk_bf16_f32 v54, v84, v85
  v_cvt_pk_bf16_f32 v55, v86, v87
  v_exp_f32 v88, v88
  v_exp_f32 v89, v89
  v_exp_f32 v90, v90
  v_exp_f32 v91, v91
  buffer_load_dwordx4 v[224:227], v128, s[4:7], s64 offen sc1
  s_add_u32 s64, s64, 1024
  v_mfma_f32_32x32x16_bf16 v[112:127], v[40:43], v[52:55], v[112:127]
  v_exp_f32 v92, v92
  v_exp_f32 v93, v93
  v_exp_f32 v94, v94
  v_exp_f32 v95, v95
  v_cvt_pk_bf16_f32 v56, v88, v89
  v_cvt_pk_bf16_f32 v57, v90, v91
  v_cvt_pk_bf16_f32 v58, v92, v93
  v_cvt_pk_bf16_f32 v59, v94, v95
  s_setprio 1
  v_mfma_f32_32x32x16_bf16 v[80:95], v[24:27], v[60:63], 0
  v_exp_f32 v64, v64
  v_exp_f32 v65, v65
  v_exp_f32 v66, v66
  v_exp_f32 v67, v67
  v_mfma_f32_32x32x16_bf16 v[112:127], v[48:51], v[56:59], v[112:127]
  ds_read_b128 v[28:31], v20 offset:27648
  ds_read_b64 v[34:35], v21 offset:27648
  v_exp_f32 v68, v68
  v_exp_f32 v69, v69
  v_exp_f32 v70, v70
  v_exp_f32 v71, v71
  v_cvt_pk_bf16_f32 v52, v64, v65
  v_cvt_pk_bf16_f32 v53, v66, v67
  v_mfma_f32_32x32x8_bf16 v[80:95], v[32:33], v[18:19], v[80:95]
  v_cvt_pk_bf16_f32 v54, v68, v69
  v_cvt_pk_bf16_f32 v55, v70, v71
  v_exp_f32 v72, v72
  v_exp_f32 v73, v73
  v_exp_f32 v74, v74
  v_exp_f32 v75, v75
  s_waitcnt lgkmcnt(2)
  buffer_load_dwordx4 v[228:231], v128, s[4:7], s64 offen sc1
  s_add_u32 s64, s64, 1024
  v_mfma_f32_32x32x16_bf16 v[96:111], v[36:39], v[52:55], v[96:111]
  v_exp_f32 v76, v76
  v_exp_f32 v77, v77
  v_exp_f32 v78, v78
  v_exp_f32 v79, v79
  v_cvt_pk_bf16_f32 v56, v72, v73
  v_cvt_pk_bf16_f32 v57, v74, v75
  v_cvt_pk_bf16_f32 v58, v76, v77
  v_cvt_pk_bf16_f32 v59, v78, v79
  s_setprio 0
  s_waitcnt lgkmcnt(0)
  v_mfma_f32_32x32x16_bf16 v[64:79], v[28:31], v[12:15], 0
  v_exp_f32 v80, v80
  v_exp_f32 v81, v81
  v_exp_f32 v82, v82
  v_exp_f32 v83, v83
  v_mfma_f32_32x32x16_bf16 v[96:111], v[44:47], v[56:59], v[96:111]
  ds_read_b128 v[40:43], v22 offset:27648
  ds_read_b128 v[48:51], v23 offset:27648
  v_exp_f32 v84, v84
  v_exp_f32 v85, v85
  v_exp_f32 v86, v86
  v_exp_f32 v87, v87
  v_cvt_pk_bf16_f32 v52, v80, v81
  v_cvt_pk_bf16_f32 v53, v82, v83
  v_mfma_f32_32x32x8_bf16 v[64:79], v[34:35], v[16:17], v[64:79]
  v_cvt_pk_bf16_f32 v54, v84, v85
  v_cvt_pk_bf16_f32 v55, v86, v87
  v_exp_f32 v88, v88
  v_exp_f32 v89, v89
  v_exp_f32 v90, v90
  v_exp_f32 v91, v91
  buffer_load_dwordx4 v[232:235], v128, s[4:7], s64 offen sc1
  s_add_u32 s64, s64, 1024
  v_mfma_f32_32x32x16_bf16 v[112:127], v[36:39], v[52:55], v[112:127]
  v_exp_f32 v92, v92
  v_exp_f32 v93, v93
  v_exp_f32 v94, v94
  v_exp_f32 v95, v95
  v_cvt_pk_bf16_f32 v56, v88, v89
  v_cvt_pk_bf16_f32 v57, v90, v91
  v_cvt_pk_bf16_f32 v58, v92, v93
  v_cvt_pk_bf16_f32 v59, v94, v95
  s_setprio 1
  v_mfma_f32_32x32x16_bf16 v[80:95], v[28:31], v[60:63], 0
  v_exp_f32 v64, v64
  v_exp_f32 v65, v65
  v_exp_f32 v66, v66
  v_exp_f32 v67, v67
  v_mfma_f32_32x32x16_bf16 v[112:127], v[44:47], v[56:59], v[112:127]
  ds_read_b128 v[24:27], v20 offset:30720
  ds_read_b64 v[32:33], v21 offset:30720
  v_exp_f32 v68, v68
  v_exp_f32 v69, v69
  v_exp_f32 v70, v70
  v_exp_f32 v71, v71
  v_cvt_pk_bf16_f32 v52, v64, v65
  v_cvt_pk_bf16_f32 v53, v66, v67
  v_mfma_f32_32x32x8_bf16 v[80:95], v[34:35], v[18:19], v[80:95]
  v_cvt_pk_bf16_f32 v54, v68, v69
  v_cvt_pk_bf16_f32 v55, v70, v71
  v_exp_f32 v72, v72
  v_exp_f32 v73, v73
  v_exp_f32 v74, v74
  v_exp_f32 v75, v75
  s_waitcnt lgkmcnt(2)
  buffer_load_dwordx4 v[236:239], v128, s[4:7], s64 offen sc1
  s_add_u32 s64, s64, 1024
  v_mfma_f32_32x32x16_bf16 v[96:111], v[40:43], v[52:55], v[96:111]
  v_exp_f32 v76, v76
  v_exp_f32 v77, v77
  v_exp_f32 v78, v78
  v_exp_f32 v79, v79
  v_cvt_pk_bf16_f32 v56, v72, v73
  v_cvt_pk_bf16_f32 v57, v74, v75
  v_cvt_pk_bf16_f32 v58, v76, v77
  v_cvt_pk_bf16_f32 v59, v78, v79
  s_setprio 0
  s_waitcnt lgkmcnt(0)
  v_mfma_f32_32x32x16_bf16 v[64:79], v[24:27], v[12:15], 0
  v_exp_f32 v80, v80
  v_exp_f32 v81, v81
  v_exp_f32 v82, v82
  v_exp_f32 v83, v83
  v_mfma_f32_32x32x16_bf16 v[96:111], v[48:51], v[56:59], v[96:111]
  ds_read_b128 v[36:39], v22 offset:30720
  ds_read_b128 v[44:47], v23 offset:30720
  v_exp_f32 v84, v84
  v_exp_f32 v85, v85
  v_exp_f32 v86, v86
  v_exp_f32 v87, v87
  v_cvt_pk_bf16_f32 v52, v80, v81
  v_cvt_pk_bf16_f32 v53, v82, v83
  v_mfma_f32_32x32x8_bf16 v[64:79], v[32:33], v[16:17], v[64:79]
  v_cvt_pk_bf16_f32 v54, v84, v85
  v_cvt_pk_bf16_f32 v55, v86, v87
  v_exp_f32 v88, v88
  v_exp_f32 v89, v89
  v_exp_f32 v90, v90
  v_exp_f32 v91, v91
  buffer_load_dwordx4 v[240:243], v128, s[4:7], s64 offen sc1
  s_add_u32 s64, s64, 1024
  v_mfma_f32_32x32x16_bf16 v[112:127], v[40:43], v[52:55], v[112:127]
  v_exp_f32 v92, v92
  v_exp_f32 v93, v93
  v_exp_f32 v94, v94
  v_exp_f32 v95, v95
  v_cvt_pk_bf16_f32 v56, v88, v89
  v_cvt_pk_bf16_f32 v57, v90, v91
  v_cvt_pk_bf16_f32 v58, v92, v93
  v_cvt_pk_bf16_f32 v59, v94, v95
  s_setprio 1
  v_mfma_f32_32x32x16_bf16 v[80:95], v[24:27], v[60:63], 0
  v_exp_f32 v64, v64
  v_exp_f32 v65, v65
  v_exp_f32 v66, v66
  v_exp_f32 v67, v67
  v_mfma_f32_32x32x16_bf16 v[112:127], v[48:51], v[56:59], v[112:127]
  ds_read_b128 v[28:31], v20 offset:33792
  ds_read_b64 v[34:35], v21 offset:33792
  v_exp_f32 v68, v68
  v_exp_f32 v69, v69
  v_exp_f32 v70, v70
  v_exp_f32 v71, v71
  v_cvt_pk_bf16_f32 v52, v64, v65
  v_cvt_pk_bf16_f32 v53, v66, v67
  v_mfma_f32_32x32x8_bf16 v[80:95], v[32:33], v[18:19], v[80:95]
  v_cvt_pk_bf16_f32 v54, v68, v69
  v_cvt_pk_bf16_f32 v55, v70, v71
  v_exp_f32 v72, v72
  v_exp_f32 v73, v73
  v_exp_f32 v74, v74
  v_exp_f32 v75, v75
  s_waitcnt lgkmcnt(2)
  buffer_load_dwordx4 v[244:247], v128, s[4:7], s64 offen sc1
  s_add_u32 s64, s64, 1024
  v_mfma_f32_32x32x16_bf16 v[96:111], v[36:39], v[52:55], v[96:111]
  v_exp_f32 v76, v76
  v_exp_f32 v77, v77
  v_exp_f32 v78, v78
  v_exp_f32 v79, v79
  v_cvt_pk_bf16_f32 v56, v72, v73
  v_cvt_pk_bf16_f32 v57, v74, v75
  v_cvt_pk_bf16_f32 v58, v76, v77
  v_cvt_pk_bf16_f32 v59, v78, v79
  s_setprio 0
  s_waitcnt lgkmcnt(0)
  v_mfma_f32_32x32x16_bf16 v[64:79], v[28:31], v[12:15], 0
  v_exp_f32 v80, v80
  v_exp_f32 v81, v81
  v_exp_f32 v82, v82
  v_exp_f32 v83, v83
  v_mfma_f32_32x32x16_bf16 v[96:111], v[44:47], v[56:59], v[96:111]
  ds_read_b128 v[40:43], v22 offset:33792
  ds_read_b128 v[48:51], v23 offset:33792
  v_exp_f32 v84, v84
  v_exp_f32 v85, v85
  v_exp_f32 v86, v86
  v_exp_f32 v87, v87
  v_cvt_pk_bf16_f32 v52, v80, v81
  v_cvt_pk_bf16_f32 v53, v82, v83
  v_mfma_f32_32x32x8_bf16 v[64:79], v[34:35], v[16:17], v[64:79]
  v_cvt_pk_bf16_f32 v54, v84, v85
  v_cvt_pk_bf16_f32 v55, v86, v87
  v_exp_f32 v88, v88
  v_exp_f32 v89, v89
  v_exp_f32 v90, v90
  v_exp_f32 v91, v91
  buffer_load_dwordx4 v[248:251], v128, s[4:7], s64 offen sc1
  s_add_u32 s64, s64, 1024
  v_mfma_f32_32x32x16_bf16 v[112:127], v[36:39], v[52:55], v[112:127]
  v_exp_f32 v92, v92
  v_exp_f32 v93, v93
  v_exp_f32 v94, v94
  v_exp_f32 v95, v95
  v_cvt_pk_bf16_f32 v56, v88, v89
  v_cvt_pk_bf16_f32 v57, v90, v91
  v_cvt_pk_bf16_f32 v58, v92, v93
  v_cvt_pk_bf16_f32 v59, v94, v95
  s_waitcnt vmcnt(6)
  s_barrier
  s_setprio 1
  v_mfma_f32_32x32x16_bf16 v[80:95], v[28:31], v[60:63], 0
  v_exp_f32 v64, v64
  v_exp_f32 v65, v65
  v_exp_f32 v66, v66
  v_exp_f32 v67, v67
  v_mfma_f32_32x32x16_bf16 v[112:127], v[44:47], v[56:59], v[112:127]
  ds_read_b128 v[24:27], v20 offset:49152
  ds_read_b64 v[32:33], v21 offset:49152
  v_exp_f32 v68, v68
  v_exp_f32 v69, v69
  v_exp_f32 v70, v70
  v_exp_f32 v71, v71
  v_cvt_pk_bf16_f32 v52, v64, v65
  v_cvt_pk_bf16_f32 v53, v66, v67
  v_mfma_f32_32x32x8_bf16 v[80:95], v[34:35], v[18:19], v[80:95]
  v_cvt_pk_bf16_f32 v54, v68, v69
  v_cvt_pk_bf16_f32 v55, v70, v71
  v_exp_f32 v72, v72
  v_exp_f32 v73, v73
  v_exp_f32 v74, v74
  v_exp_f32 v75, v75
  s_waitcnt lgkmcnt(2)
  buffer_load_dwordx4 v[252:255], v128, s[4:7], s64 offen sc1
  s_add_u32 s64, s64, 1024
  v_mfma_f32_32x32x16_bf16 v[96:111], v[40:43], v[52:55], v[96:111]
  v_exp_f32 v76, v76
  v_exp_f32 v77, v77
  v_exp_f32 v78, v78
  v_exp_f32 v79, v79
  v_cvt_pk_bf16_f32 v56, v72, v73
  v_cvt_pk_bf16_f32 v57, v74, v75
  v_cvt_pk_bf16_f32 v58, v76, v77
  v_cvt_pk_bf16_f32 v59, v78, v79
  s_setprio 0
  s_waitcnt lgkmcnt(0)
  v_mfma_f32_32x32x16_bf16 v[64:79], v[24:27], v[12:15], 0
  v_exp_f32 v80, v80
  v_exp_f32 v81, v81
  v_exp_f32 v82, v82
  v_exp_f32 v83, v83
  v_mfma_f32_32x32x16_bf16 v[96:111], v[48:51], v[56:59], v[96:111]
  ds_read_b128 v[36:39], v22 offset:49152
  ds_read_b128 v[44:47], v23 offset:49152
  v_exp_f32 v84, v84
  v_exp_f32 v85, v85
  v_exp_f32 v86, v86
  v_exp_f32 v87, v87
  v_cvt_pk_bf16_f32 v52, v80, v81
  v_cvt_pk_bf16_f32 v53, v82, v83
  v_mfma_f32_32x32x8_bf16 v[64:79], v[32:33], v[16:17], v[64:79]
  v_cvt_pk_bf16_f32 v54, v84, v85
  v_cvt_pk_bf16_f32 v55, v86, v87
  v_exp_f32 v88, v88
  v_exp_f32 v89, v89
  v_exp_f32 v90, v90
  v_exp_f32 v91, v91
  v_mfma_f32_32x32x16_bf16 v[112:127], v[40:43], v[52:55], v[112:127]
  v_exp_f32 v92, v92
  v_exp_f32 v93, v93
  v_exp_f32 v94, v94
  v_exp_f32 v95, v95
  v_cvt_pk_bf16_f32 v56, v88, v89
  v_cvt_pk_bf16_f32 v57, v90, v91
  v_cvt_pk_bf16_f32 v58, v92, v93
  v_cvt_pk_bf16_f32 v59, v94, v95
  s_waitcnt vmcnt(0) lgkmcnt(0)
  s_nop 0
  v_mfma_f32_32x32x16_bf16 v[112:127], v[48:51], v[56:59], v[112:127]
  s_setprio 0
  s_mul_i32 s43, s32, 3072
  s_add_u32 s43, s43, 0
  v_add_u32 v24, s43, v128
  s_xor_b32 s44, s32, 4
  s_mul_i32 s44, s44, 3072
  s_add_u32 s44, s44, 0
  v_add_u32 v25, s44, v128
  s_nop 3
  ds_write_b128 v24, v[112:115] offset:0
  ds_write_b128 v24, v[116:119] offset:1024
  ds_write_b128 v24, v[120:123] offset:2048
  s_waitcnt lgkmcnt(0)
  s_barrier
  ds_read_b128 v[64:67], v25 offset:0
  ds_read_b128 v[68:71], v25 offset:1024
  ds_read_b128 v[72:75], v25 offset:2048
  s_waitcnt lgkmcnt(0)
  v_add_f32 v96, v96, v64
  v_add_f32 v97, v97, v65
  v_add_f32 v98, v98, v66
  v_add_f32 v99, v99, v67
  v_add_f32 v100, v100, v68
  v_add_f32 v101, v101, v69
  v_add_f32 v102, v102, v70
  v_add_f32 v103, v103, v71
  v_add_f32 v104, v104, v72
  v_add_f32 v105, v105, v73
  v_add_f32 v106, v106, v74
  v_add_f32 v107, v107, v75
  v_mov_b32 v10, v104
  v_mov_b32 v2, v104
  s_nop 1
  v_permlane32_swap_b32 v10, v2
  v_cmp_nle_f32 vcc, 0x1f800000, v2
  s_cmp_eq_u64 vcc, 0
  s_cbranch_scc1 P2_fin_80
  s_lshl_b32 s43, s36, 6
  s_mul_i32 s48, s43, 2560
  s_add_u32 s48, s48, 2756608
  s_mov_b32 s50, s48
  s_mul_i32 s44, s42, 12288
  v_subrev_u32 v21, s44, v21
  v_subrev_u32 v22, s44, v22
  v_subrev_u32 v23, s44, v23
  v_mov_b32 v11, 0xff800000
  s_mov_b32 s49, 0
P2_fb1_81:
  v_mov_b32 v32, 0
  v_mov_b32 v33, 0
  buffer_load_dwordx4 v[24:27], v128, s[4:7], s48 offen sc1
  s_mov_b64 exec, 0xffffffff
  buffer_load_dwordx2 v[32:33], v21, s[4:7], s48 offen sc1
  s_mov_b64 exec, -1
  s_waitcnt vmcnt(0)
  v_mfma_f32_32x32x16_bf16 v[64:79], v[24:27], v[12:15], 0
  v_mfma_f32_32x32x8_bf16 v[64:79], v[32:33], v[16:17], v[64:79]
  s_nop 11
  v_max_f32 v11, v11, v64
  v_max_f32 v11, v11, v65
  v_max_f32 v11, v11, v66
  v_max_f32 v11, v11, v67
  v_max_f32 v11, v11, v68
  v_max_f32 v11, v11, v69
  v_max_f32 v11, v11, v70
  v_max_f32 v11, v11, v71
  v_max_f32 v11, v11, v72
  v_max_f32 v11, v11, v73
  v_max_f32 v11, v11, v74
  v_max_f32 v11, v11, v75
  v_max_f32 v11, v11, v76
  v_max_f32 v11, v11, v77
  v_max_f32 v11, v11, v78
  v_max_f32 v11, v11, v79
  s_add_u32 s48, s48, 2560
  s_add_u32 s49, s49, 1
  s_cmp_lt_u32 s49, 64
  s_cbranch_scc1 P2_fb1_81
  v_mov_b32 v2, v11
  s_nop 1
  v_permlane32_swap_b32 v11, v2
  v_max_f32 v11, v11, v2
  v_sub_f32 v11, 0, v11
  v_and_b32 v2, 0xffff0000, v11
  v_sub_f32 v3, v11, v2
  v_and_b32 v4, 0xffff0000, v3
  v_sub_f32 v3, v3, v4
  v_lshrrev_b32 v2, 16, v2
  v_or_b32 v2, v2, v4
  v_lshrrev_b32 v3, 16, v3
  v_cmp_eq_u32 vcc, 1, v9
  s_nop 1
  v_cndmask_b32 v16, v16, v2, vcc
  v_cndmask_b32 v17, v17, v3, vcc
  v_mov_b32 v96, 0
  v_mov_b32 v97, 0
  v_mov_b32 v98, 0
  v_mov_b32 v99, 0
  v_mov_b32 v100, 0
  v_mov_b32 v101, 0
  v_mov_b32 v102, 0
  v_mov_b32 v103, 0
  v_mov_b32 v104, 0
  v_mov_b32 v105, 0
  v_mov_b32 v106, 0
  v_mov_b32 v107, 0
  v_mov_b32 v108, 0
  v_mov_b32 v109, 0
  v_mov_b32 v110, 0
  v_mov_b32 v111, 0
  s_mov_b32 s48, s50
  s_mov_b32 s49, 0
  v_cmp_eq_u32 vcc, 1, v9
  v_mov_b32 v2, 0x3f803f80
  v_mov_b32 v3, 0x00003f80
  v_mov_b32 v4, 0
  v_cndmask_b32 v32, v4, v2, vcc
  v_cndmask_b32 v33, v4, v3, vcc
  v_cmp_eq_u32 vcc, 20, v8
  s_nop 1
  v_cndmask_b32 v5, v4, v2, vcc
  v_mov_b32 v36, v5
  v_mov_b32 v44, v5
  v_mov_b32 v37, v5
  v_mov_b32 v45, v5
  v_mov_b32 v38, v5
  v_mov_b32 v46, v5
  v_mov_b32 v39, v5
  v_mov_b32 v47, v5
  v_cmp_gt_u32 vcc, 20, v8
  s_mov_b64 s[54:55], vcc
P2_fb2_82:
  buffer_load_dwordx4 v[24:27], v128, s[4:7], s48 offen sc1
  s_mov_b64 exec, 0xffffffff
  buffer_load_dwordx2 v[32:33], v21, s[4:7], s48 offen sc1
  s_mov_b64 exec, s[54:55]
  buffer_load_dwordx4 v[36:39], v22, s[4:7], s48 offen sc1
  buffer_load_dwordx4 v[44:47], v23, s[4:7], s48 offen sc1
  s_mov_b64 exec, -1
  s_waitcnt vmcnt(0)
  v_mfma_f32_32x32x16_bf16 v[64:79], v[24:27], v[12:15], 0
  v_mfma_f32_32x32x8_bf16 v[64:79], v[32:33], v[16:17], v[64:79]
  s_nop 11
  v_exp_f32 v64, v64
  v_exp_f32 v65, v65
  v_exp_f32 v66, v66
  v_exp_f32 v67, v67
  v_exp_f32 v68, v68
  v_exp_f32 v69, v69
  v_exp_f32 v70, v70
  v_exp_f32 v71, v71
  v_exp_f32 v72, v72
  v_exp_f32 v73, v73
  v_exp_f32 v74, v74
  v_exp_f32 v75, v75
  v_exp_f32 v76, v76
  v_exp_f32 v77, v77
  v_exp_f32 v78, v78
  v_exp_f32 v79, v79
  v_cvt_pk_bf16_f32 v52, v64, v65
  v_cvt_pk_bf16_f32 v53, v66, v67
  v_cvt_pk_bf16_f32 v54, v68, v69
  v_cvt_pk_bf16_f32 v55, v70, v71
  v_cvt_pk_bf16_f32 v56, v72, v73
  v_cvt_pk_bf16_f32 v57, v74, v75
  v_cvt_pk_bf16_f32 v58, v76, v77
  v_cvt_pk_bf16_f32 v59, v78, v79
  v_mfma_f32_32x32x16_bf16 v[96:111], v[36:39], v[52:55], v[96:111]
  s_nop 0
  v_mfma_f32_32x32x16_bf16 v[96:111], v[44:47], v[56:59], v[96:111]
  s_add_u32 s48, s48, 2560
  s_add_u32 s49, s49, 1
  s_cmp_lt_u32 s49, 64
  s_cbranch_scc1 P2_fb2_82
  s_nop 7
  v_mov_b32 v10, v104
  v_mov_b32 v2, v104
  s_nop 1
  v_permlane32_swap_b32 v10, v2
P2_fin_80:
  v_rcp_f32 v2, v2
  s_nop 0
  v_mul_f32 v96, v96, v2
  v_mul_f32 v97, v97, v2
  v_mul_f32 v98, v98, v2
  v_mul_f32 v99, v99, v2
  v_mul_f32 v100, v100, v2
  v_mul_f32 v101, v101, v2
  v_mul_f32 v102, v102, v2
  v_mul_f32 v103, v103, v2
  v_mul_f32 v104, v104, v2
  v_mul_f32 v105, v105, v2
  v_mul_f32 v106, v106, v2
  v_mul_f32 v107, v107, v2
  v_cvt_pk_bf16_f32 v52, v96, v97
  v_cvt_pk_bf16_f32 v53, v98, v99
  v_cvt_pk_bf16_f32 v54, v100, v101
  v_cvt_pk_bf16_f32 v55, v102, v103
  v_cvt_pk_bf16_f32 v56, v104, v105
  v_cvt_pk_bf16_f32 v57, v106, v107
  v_min_u32 v52, 0xfffffffe, v52
  v_min_u32 v53, 0xfffffffe, v53
  v_min_u32 v54, 0xfffffffe, v54
  v_min_u32 v55, 0xfffffffe, v55
  v_min_u32 v56, 0xfffffffe, v56
  v_min_u32 v57, 0xfffffffe, v57
  v_permlane32_swap_b32 v52, v54
  v_permlane32_swap_b32 v53, v55
  buffer_store_dwordx4 v[52:55], v130, s[4:7], s46 offen sc1
  s_mov_b64 exec, 0xffffffff
  buffer_store_dwordx2 v[56:57], v131, s[4:7], s46 offen sc1
  s_mov_b64 exec, -1
  s_barrier
  s_lshl_b32 s54, s32, 10
  s_add_u32 m0, s54, 61440
  s_add_u32 s55, s54, s65
  buffer_load_dwordx4 v128, s[4:7], s55 offen sc1 lds
  s_cmp_ge_u32 s32, 4
  s_cbranch_scc1 wo_late_83
  s_add_u32 m0, s54, 69632
  s_add_u32 s55, s55, 8192
  buffer_load_dwordx4 v128, s[4:7], s55 offen sc1 lds
wo_late_83:
  s_lshr_b32 s38, s34, 3
  s_lshl_b32 s36, s33, 2
  s_add_u32 s36, s36, s38
  s_and_b32 s37, s34, 7
  s_and_b32 s38, s32, 3
  s_lshr_b32 s39, s32, 2
  v_lshlrev_b32 v22, 4, v1
  v_and_b32 v8, 15, v1
  v_lshrrev_b32 v9, 4, v1
  s_lshl_b32 s40, s36, 6
  s_lshl_b32 s41, s38, 4
  s_add_u32 s40, s40, s41
  s_mul_i32 s40, s40, 1280
  s_mul_i32 s41, s37, 160
  s_add_u32 s40, s40, s41
  s_mul_i32 s41, s39, 96
  s_add_u32 s44, s40, s41
  v_mul_u32_u24 v2, 1280, v8
  v_lshl_add_u32 v23, v9, 3, v2
  buffer_load_dwordx2 v[124:125], v23, s[8:11], s44 offen offset:0
  buffer_load_dwordx2 v[126:127], v23, s[8:11], s44 offen offset:32
  buffer_load_dwordx2 v[128:129], v23, s[8:11], s44 offen offset:64
  s_mul_i32 s40, s39, 10240
  s_add_u32 s40, s40, 61440
  v_add_u32 v20, s40, v22
  v_add_u32 v21, 61440, v20
  s_mul_i32 s43, s36, 81920
  s_mul_i32 s40, s39, 40960
  s_add_u32 s43, s43, s40
  s_lshl_b32 s40, s38, 10
  s_add_u32 s43, s43, s40
  s_add_u32 s43, s43, 8118272
  v_and_b32 v2, 15, v1
  v_bfe_u32 v3, v1, 4, 1
  v_cmp_eq_u32 vcc, v2, v3
  v_mov_b32 v4, 0x3f803f80
  v_mov_b32 v5, 0
  v_cndmask_b32 v16, v5, v4, vcc
  v_mov_b32 v17, v16
  v_mov_b32 v18, v16
  v_mov_b32 v19, v16
  s_nop 1
  v_mfma_f32_16x16x32_bf16 v[12:15], v[16:19], v[132:135], 0
  v_mfma_f32_16x16x32_bf16 v[12:15], v[16:19], v[136:139], v[12:15]
  v_mfma_f32_16x16x32_bf16 v[12:15], v[16:19], v[140:143], v[12:15]
  v_mfma_f32_16x16x32_bf16 v[12:15], v[16:19], v[144:147], v[12:15]
  v_mfma_f32_16x16x32_bf16 v[12:15], v[16:19], v[148:151], v[12:15]
  v_mfma_f32_16x16x32_bf16 v[12:15], v[16:19], v[152:155], v[12:15]
  v_mfma_f32_16x16x32_bf16 v[12:15], v[16:19], v[156:159], v[12:15]
  v_mfma_f32_16x16x32_bf16 v[12:15], v[16:19], v[160:163], v[12:15]
  v_mfma_f32_16x16x32_bf16 v[12:15], v[16:19], v[164:167], v[12:15]
  v_mfma_f32_16x16x32_bf16 v[12:15], v[16:19], v[168:171], v[12:15]
  v_mfma_f32_16x16x32_bf16 v[12:15], v[16:19], v[172:175], v[12:15]
  v_mfma_f32_16x16x32_bf16 v[12:15], v[16:19], v[176:179], v[12:15]
  v_mfma_f32_16x16x32_bf16 v[12:15], v[16:19], v[180:183], v[12:15]
  v_mfma_f32_16x16x32_bf16 v[12:15], v[16:19], v[184:187], v[12:15]
  v_mfma_f32_16x16x32_bf16 v[12:15], v[16:19], v[188:191], v[12:15]
  v_mfma_f32_16x16x32_bf16 v[12:15], v[16:19], v[192:195], v[12:15]
  v_mfma_f32_16x16x32_bf16 v[12:15], v[16:19], v[196:199], v[12:15]
  v_mfma_f32_16x16x32_bf16 v[12:15], v[16:19], v[200:203], v[12:15]
  v_mfma_f32_16x16x32_bf16 v[12:15], v[16:19], v[204:207], v[12:15]
  v_mfma_f32_16x16x32_bf16 v[12:15], v[16:19], v[208:211], v[12:15]
  v_mfma_f32_16x16x32_bf16 v[12:15], v[16:19], v[212:215], v[12:15]
  v_mfma_f32_16x16x32_bf16 v[12:15], v[16:19], v[216:219], v[12:15]
  v_mfma_f32_16x16x32_bf16 v[12:15], v[16:19], v[220:223], v[12:15]
  v_mfma_f32_16x16x32_bf16 v[12:15], v[16:19], v[224:227], v[12:15]
  v_mfma_f32_16x16x32_bf16 v[12:15], v[16:19], v[228:231], v[12:15]
  v_mfma_f32_16x16x32_bf16 v[12:15], v[16:19], v[232:235], v[12:15]
  v_mfma_f32_16x16x32_bf16 v[12:15], v[16:19], v[236:239], v[12:15]
  v_mfma_f32_16x16x32_bf16 v[12:15], v[16:19], v[240:243], v[12:15]
  v_mfma_f32_16x16x32_bf16 v[12:15], v[16:19], v[244:247], v[12:15]
  v_mfma_f32_16x16x32_bf16 v[12:15], v[16:19], v[248:251], v[12:15]
  v_mfma_f32_16x16x32_bf16 v[12:15], v[16:19], v[252:255], v[12:15]
  s_waitcnt vmcnt(0)
  s_barrier
  s_add_u32 s40, s43, 0
  buffer_load_dwordx4 v[24:27], v22, s[4:7], s40 offen sc1
  s_add_u32 s40, s43, 4096
  buffer_load_dwordx4 v[28:31], v22, s[4:7], s40 offen sc1
  s_add_u32 s40, s43, 8192
  buffer_load_dwordx4 v[32:35], v22, s[4:7], s40 offen sc1
  s_add_u32 s40, s43, 12288
  buffer_load_dwordx4 v[36:39], v22, s[4:7], s40 offen sc1
  s_add_u32 s40, s43, 16384
  buffer_load_dwordx4 v[40:43], v22, s[4:7], s40 offen sc1
  s_add_u32 s40, s43, 20480
  buffer_load_dwordx4 v[44:47], v22, s[4:7], s40 offen sc1
  s_add_u32 s40, s43, 24576
  buffer_load_dwordx4 v[48:51], v22, s[4:7], s40 offen sc1
  s_add_u32 s40, s43, 28672
  buffer_load_dwordx4 v[52:55], v22, s[4:7], s40 offen sc1
  s_add_u32 s40, s43, 32768
  buffer_load_dwordx4 v[56:59], v22, s[4:7], s40 offen sc1
  s_add_u32 s40, s43, 36864
  buffer_load_dwordx4 v[60:63], v22, s[4:7], s40 offen sc1
  s_mov_b32 s61, 0
pf_top_84:
  s_waitcnt vmcnt(0)
  s_mov_b32 s62, 0
  v_max3_u32 v3, v24, v25, v26
  v_max_u32 v3, v3, v27
  v_cmp_eq_u32 vcc, -1, v3
  s_cmp_eq_u64 vcc, 0
  s_cbranch_scc1 pf_n_86
  s_mov_b32 s62, 1
  s_add_u32 s40, s43, 0
  buffer_load_dwordx4 v[24:27], v22, s[4:7], s40 offen sc1
pf_n_86:
  v_max3_u32 v3, v28, v29, v30
  v_max_u32 v3, v3, v31
  v_cmp_eq_u32 vcc, -1, v3
  s_cmp_eq_u64 vcc, 0
  s_cbranch_scc1 pf_n_87
  s_mov_b32 s62, 1
  s_add_u32 s40, s43, 4096
  buffer_load_dwordx4 v[28:31], v22, s[4:7], s40 offen sc1
pf_n_87:
  v_max3_u32 v3, v32, v33, v34
  v_max_u32 v3, v3, v35
  v_cmp_eq_u32 vcc, -1, v3
  s_cmp_eq_u64 vcc, 0
  s_cbranch_scc1 pf_n_88
  s_mov_b32 s62, 1
  s_add_u32 s40, s43, 8192
  buffer_load_dwordx4 v[32:35], v22, s[4:7], s40 offen sc1
pf_n_88:
  v_max3_u32 v3, v36, v37, v38
  v_max_u32 v3, v3, v39
  v_cmp_eq_u32 vcc, -1, v3
  s_cmp_eq_u64 vcc, 0
  s_cbranch_scc1 pf_n_89
  s_mov_b32 s62, 1
  s_add_u32 s40, s43, 12288
  buffer_load_dwordx4 v[36:39], v22, s[4:7], s40 offen sc1
pf_n_89:
  v_max3_u32 v3, v40, v41, v42
  v_max_u32 v3, v3, v43
  v_cmp_eq_u32 vcc, -1, v3
  s_cmp_eq_u64 vcc, 0
  s_cbranch_scc1 pf_n_90
  s_mov_b32 s62, 1
  s_add_u32 s40, s43, 16384
  buffer_load_dwordx4 v[40:43], v22, s[4:7], s40 offen sc1
pf_n_90:
  v_max3_u32 v3, v44, v45, v46
  v_max_u32 v3, v3, v47
  v_cmp_eq_u32 vcc, -1, v3
  s_cmp_eq_u64 vcc, 0
  s_cbranch_scc1 pf_n_91
  s_mov_b32 s62, 1
  s_add_u32 s40, s43, 20480
  buffer_load_dwordx4 v[44:47], v22, s[4:7], s40 offen sc1
pf_n_91:
  v_max3_u32 v3, v48, v49, v50
  v_max_u32 v3, v3, v51
  v_cmp_eq_u32 vcc, -1, v3
  s_cmp_eq_u64 vcc, 0
  s_cbranch_scc1 pf_n_92
  s_mov_b32 s62, 1
  s_add_u32 s40, s43, 24576
  buffer_load_dwordx4 v[48:51], v22, s[4:7], s40 offen sc1
pf_n_92:
  v_max3_u32 v3, v52, v53, v54
  v_max_u32 v3, v3, v55
  v_cmp_eq_u32 vcc, -1, v3
  s_cmp_eq_u64 vcc, 0
  s_cbranch_scc1 pf_n_93
  s_mov_b32 s62, 1
  s_add_u32 s40, s43, 28672
  buffer_load_dwordx4 v[52:55], v22, s[4:7], s40 offen sc1
pf_n_93:
  v_max3_u32 v3, v56, v57, v58
  v_max_u32 v3, v3, v59
  v_cmp_eq_u32 vcc, -1, v3
  s_cmp_eq_u64 vcc, 0
  s_cbranch_scc1 pf_n_94
  s_mov_b32 s62, 1
  s_add_u32 s40, s43, 32768
  buffer_load_dwordx4 v[56:59], v22, s[4:7], s40 offen sc1
pf_n_94:
  v_max3_u32 v3, v60, v61, v62
  v_max_u32 v3, v3, v63
  v_cmp_eq_u32 vcc, -1, v3
  s_cmp_eq_u64 vcc, 0
  s_cbranch_scc1 pf_n_95
  s_mov_b32 s62, 1
  s_add_u32 s40, s43, 36864
  buffer_load_dwordx4 v[60:63], v22, s[4:7], s40 offen sc1
pf_n_95:
  s_cmp_eq_u32 s62, 0
  s_cbranch_scc1 pf_ok_85
  s_add_u32 s61, s61, 1
  s_cmp_lt_u32 s61, 1048576
  s_cbranch_scc1 pf_top_84
  s_waitcnt vmcnt(0)
pf_ok_85:
  ds_read_b128 v[64:67], v20 offset:0
  ds_read_b128 v[68:71], v20 offset:20480
  ds_read_b128 v[72:75], v20 offset:40960
  ds_read_b128 v[76:79], v21 offset:0
  ds_read_b128 v[80:83], v21 offset:20480
  ds_read_b128 v[84:87], v20 offset:1024
  ds_read_b128 v[88:91], v20 offset:21504
  ds_read_b128 v[92:95], v20 offset:41984
  ds_read_b128 v[96:99], v21 offset:1024
  ds_read_b128 v[100:103], v21 offset:21504
  s_waitcnt lgkmcnt(5)
  v_mfma_f32_16x16x32_bf16 v[104:107], v[64:67], v[24:27], 0
  v_mfma_f32_16x16x32_bf16 v[108:111], v[68:71], v[24:27], 0
  v_mfma_f32_16x16x32_bf16 v[112:115], v[72:75], v[24:27], 0
  v_mfma_f32_16x16x32_bf16 v[116:119], v[76:79], v[24:27], 0
  v_mfma_f32_16x16x32_bf16 v[120:123], v[80:83], v[24:27], 0
  ds_read_b128 v[64:67], v20 offset:2048
  ds_read_b128 v[68:71], v20 offset:22528
  ds_read_b128 v[72:75], v20 offset:43008
  ds_read_b128 v[76:79], v21 offset:2048
  ds_read_b128 v[80:83], v21 offset:22528
  s_waitcnt lgkmcnt(5)
  v_mfma_f32_16x16x32_bf16 v[104:107], v[84:87], v[28:31], v[104:107]
  v_mfma_f32_16x16x32_bf16 v[108:111], v[88:91], v[28:31], v[108:111]
  v_mfma_f32_16x16x32_bf16 v[112:115], v[92:95], v[28:31], v[112:115]
  v_mfma_f32_16x16x32_bf16 v[116:119], v[96:99], v[28:31], v[116:119]
  v_mfma_f32_16x16x32_bf16 v[120:123], v[100:103], v[28:31], v[120:123]
  ds_read_b128 v[84:87], v20 offset:3072
  ds_read_b128 v[88:91], v20 offset:23552
  ds_read_b128 v[92:95], v20 offset:44032
  ds_read_b128 v[96:99], v21 offset:3072
  ds_read_b128 v[100:103], v21 offset:23552
  s_waitcnt lgkmcnt(5)
  v_mfma_f32_16x16x32_bf16 v[104:107], v[64:67], v[32:35], v[104:107]
  v_mfma_f32_16x16x32_bf16 v[108:111], v[68:71], v[32:35], v[108:111]
  v_mfma_f32_16x16x32_bf16 v[112:115], v[72:75], v[32:35], v[112:115]
  v_mfma_f32_16x16x32_bf16 v[116:119], v[76:79], v[32:35], v[116:119]
  v_mfma_f32_16x16x32_bf16 v[120:123], v[80:83], v[32:35], v[120:123]
  ds_read_b128 v[64:67], v20 offset:4096
  ds_read_b128 v[68:71], v20 offset:24576
  ds_read_b128 v[72:75], v20 offset:45056
  ds_read_b128 v[76:79], v21 offset:4096
  ds_read_b128 v[80:83], v21 offset:24576
  s_waitcnt lgkmcnt(5)
  v_mfma_f32_16x16x32_bf16 v[104:107], v[84:87], v[36:39], v[104:107]
  v_mfma_f32_16x16x32_bf16 v[108:111], v[88:91], v[36:39], v[108:111]
  v_mfma_f32_16x16x32_bf16 v[112:115], v[92:95], v[36:39], v[112:115]
  v_mfma_f32_16x16x32_bf16 v[116:119], v[96:99], v[36:39], v[116:119]
  v_mfma_f32_16x16x32_bf16 v[120:123], v[100:103], v[36:39], v[120:123]
  ds_read_b128 v[84:87], v20 offset:5120
  ds_read_b128 v[88:91], v20 offset:25600
  ds_read_b128 v[92:95], v20 offset:46080
  ds_read_b128 v[96:99], v21 offset:5120
  ds_read_b128 v[100:103], v21 offset:25600
  s_waitcnt lgkmcnt(5)
  v_mfma_f32_16x16x32_bf16 v[104:107], v[64:67], v[40:43], v[104:107]
  v_mfma_f32_16x16x32_bf16 v[108:111], v[68:71], v[40:43], v[108:111]
  v_mfma_f32_16x16x32_bf16 v[112:115], v[72:75], v[40:43], v[112:115]
  v_mfma_f32_16x16x32_bf16 v[116:119], v[76:79], v[40:43], v[116:119]
  v_mfma_f32_16x16x32_bf16 v[120:123], v[80:83], v[40:43], v[120:123]
  ds_read_b128 v[64:67], v20 offset:6144
  ds_read_b128 v[68:71], v20 offset:26624
  ds_read_b128 v[72:75], v20 offset:47104
  ds_read_b128 v[76:79], v21 offset:6144
  ds_read_b128 v[80:83], v21 offset:26624
  s_waitcnt lgkmcnt(5)
  v_mfma_f32_16x16x32_bf16 v[104:107], v[84:87], v[44:47], v[104:107]
  v_mfma_f32_16x16x32_bf16 v[108:111], v[88:91], v[44:47], v[108:111]
  v_mfma_f32_16x16x32_bf16 v[112:115], v[92:95], v[44:47], v[112:115]
  v_mfma_f32_16x16x32_bf16 v[116:119], v[96:99], v[44:47], v[116:119]
  v_mfma_f32_16x16x32_bf16 v[120:123], v[100:103], v[44:47], v[120:123]
  ds_read_b128 v[84:87], v20 offset:7168
  ds_read_b128 v[88:91], v20 offset:27648
  ds_read_b128 v[92:95], v20 offset:48128
  ds_read_b128 v[96:99], v21 offset:7168
  ds_read_b128 v[100:103], v21 offset:27648
  s_waitcnt lgkmcnt(5)
  v_mfma_f32_16x16x32_bf16 v[104:107], v[64:67], v[48:51], v[104:107]
  v_mfma_f32_16x16x32_bf16 v[108:111], v[68:71], v[48:51], v[108:111]
  v_mfma_f32_16x16x32_bf16 v[112:115], v[72:75], v[48:51], v[112:115]
  v_mfma_f32_16x16x32_bf16 v[116:119], v[76:79], v[48:51], v[116:119]
  v_mfma_f32_16x16x32_bf16 v[120:123], v[80:83], v[48:51], v[120:123]
  ds_read_b128 v[64:67], v20 offset:8192
  ds_read_b128 v[68:71], v20 offset:28672
  ds_read_b128 v[72:75], v20 offset:49152
  ds_read_b128 v[76:79], v21 offset:8192
  ds_read_b128 v[80:83], v21 offset:28672
  s_waitcnt lgkmcnt(5)
  v_mfma_f32_16x16x32_bf16 v[104:107], v[84:87], v[52:55], v[104:107]
  v_mfma_f32_16x16x32_bf16 v[108:111], v[88:91], v[52:55], v[108:111]
  v_mfma_f32_16x16x32_bf16 v[112:115], v[92:95], v[52:55], v[112:115]
  v_mfma_f32_16x16x32_bf16 v[116:119], v[96:99], v[52:55], v[116:119]
  v_mfma_f32_16x16x32_bf16 v[120:123], v[100:103], v[52:55], v[120:123]
  ds_read_b128 v[84:87], v20 offset:9216
  ds_read_b128 v[88:91], v20 offset:29696
  ds_read_b128 v[92:95], v20 offset:50176
  ds_read_b128 v[96:99], v21 offset:9216
  ds_read_b128 v[100:103], v21 offset:29696
  s_waitcnt lgkmcnt(5)
  v_mfma_f32_16x16x32_bf16 v[104:107], v[64:67], v[56:59], v[104:107]
  v_mfma_f32_16x16x32_bf16 v[108:111], v[68:71], v[56:59], v[108:111]
  v_mfma_f32_16x16x32_bf16 v[112:115], v[72:75], v[56:59], v[112:115]
  v_mfma_f32_16x16x32_bf16 v[116:119], v[76:79], v[56:59], v[116:119]
  v_mfma_f32_16x16x32_bf16 v[120:123], v[80:83], v[56:59], v[120:123]
  s_waitcnt lgkmcnt(0)
  v_mfma_f32_16x16x32_bf16 v[104:107], v[84:87], v[60:63], v[104:107]
  v_mfma_f32_16x16x32_bf16 v[108:111], v[88:91], v[60:63], v[108:111]
  v_mfma_f32_16x16x32_bf16 v[112:115], v[92:95], v[60:63], v[112:115]
  v_mfma_f32_16x16x32_bf16 v[116:119], v[96:99], v[60:63], v[116:119]
  v_mfma_f32_16x16x32_bf16 v[120:123], v[100:103], v[60:63], v[120:123]
  s_mul_i32 s40, s32, 5120
  s_add_u32 s40, s40, 0
  v_add_u32 v2, s40, v22
  s_nop 0
  ds_write_b128 v2, v[104:107] offset:0
  ds_write_b128 v2, v[108:111] offset:1024
  ds_write_b128 v2, v[112:115] offset:2048
  ds_write_b128 v2, v[116:119] offset:3072
  ds_write_b128 v2, v[120:123] offset:4096
  s_waitcnt lgkmcnt(0)
  s_barrier
  s_mul_i32 s40, s38, 5120
  s_mul_i32 s41, s39, 3072
  s_add_u32 s40, s40, s41
  s_add_u32 s40, s40, 0
  v_add_u32 v2, s40, v22
  ds_read_b128 v[24:27], v2 offset:0
  ds_read_b128 v[36:39], v2 offset:20480
  ds_read_b128 v[28:31], v2 offset:1024
  ds_read_b128 v[40:43], v2 offset:21504
  ds_read_b128 v[32:35], v2 offset:2048
  ds_read_b128 v[44:47], v2 offset:22528
  v_mov_b32 v48, 0
  v_mov_b32 v49, 0
  s_mul_i32 s40, s36, 40
  s_mul_i32 s41, s37, 5
  s_add_u32 s40, s40, s41
  s_mul_i32 s41, s39, 3
  s_add_u32 s40, s40, s41
  s_lshl_b32 s40, s40, 11
  s_lshr_b32 s41, s38, 1
  s_lshl_b32 s41, s41, 10
  s_add_u32 s40, s40, s41
  s_and_b32 s41, s38, 1
  s_lshl_b32 s41, s41, 8
  s_add_u32 s40, s40, s41
  s_add_u32 s45, s40, 10739712
  v_lshrrev_b32 v3, 1, v9
  v_lshlrev_b32 v3, 9, v3
  v_lshl_add_u32 v3, v8, 4, v3
  v_and_b32 v4, 1, v9
  v_lshl_add_u32 v50, v4, 11, v3
  s_waitcnt lgkmcnt(0)
  v_add_f32 v24, v24, v36
  v_add_f32 v25, v25, v37
  v_add_f32 v26, v26, v38
  v_add_f32 v27, v27, v39
  v_lshlrev_b32 v36, 16, v124
  v_and_b32 v37, 0xffff0000, v124
  v_lshlrev_b32 v38, 16, v125
  v_and_b32 v39, 0xffff0000, v125
  v_add_f32 v24, v24, v36
  v_add_f32 v25, v25, v37
  v_add_f32 v26, v26, v38
  v_add_f32 v27, v27, v39
  v_cvt_pk_bf16_f32 v52, v24, v25
  v_cvt_pk_bf16_f32 v53, v26, v27
  v_add_f32 v48, v48, v24
  v_fmac_f32 v49, v24, v24
  v_add_f32 v48, v48, v25
  v_fmac_f32 v49, v25, v25
  v_add_f32 v48, v48, v26
  v_fmac_f32 v49, v26, v26
  v_add_f32 v48, v48, v27
  v_fmac_f32 v49, v27, v27
  v_add_f32 v28, v28, v40
  v_add_f32 v29, v29, v41
  v_add_f32 v30, v30, v42
  v_add_f32 v31, v31, v43
  v_lshlrev_b32 v40, 16, v126
  v_and_b32 v41, 0xffff0000, v126
  v_lshlrev_b32 v42, 16, v127
  v_and_b32 v43, 0xffff0000, v127
  v_add_f32 v28, v28, v40
  v_add_f32 v29, v29, v41
  v_add_f32 v30, v30, v42
  v_add_f32 v31, v31, v43
  v_cvt_pk_bf16_f32 v54, v28, v29
  v_cvt_pk_bf16_f32 v55, v30, v31
  v_add_f32 v48, v48, v28
  v_fmac_f32 v49, v28, v28
  v_add_f32 v48, v48, v29
  v_fmac_f32 v49, v29, v29
  v_add_f32 v48, v48, v30
  v_fmac_f32 v49, v30, v30
  v_add_f32 v48, v48, v31
  v_fmac_f32 v49, v31, v31
  s_cmp_eq_u32 s39, 1
  s_cbranch_scc1 P3_skip_96
  v_add_f32 v32, v32, v44
  v_add_f32 v33, v33, v45
  v_add_f32 v34, v34, v46
  v_add_f32 v35, v35, v47
  v_lshlrev_b32 v44, 16, v128
  v_and_b32 v45, 0xffff0000, v128
  v_lshlrev_b32 v46, 16, v129
  v_and_b32 v47, 0xffff0000, v129
  v_add_f32 v32, v32, v44
  v_add_f32 v33, v33, v45
  v_add_f32 v34, v34, v46
  v_add_f32 v35, v35, v47
  v_cvt_pk_bf16_f32 v56, v32, v33
  v_cvt_pk_bf16_f32 v57, v34, v35
  v_add_f32 v48, v48, v32
  v_fmac_f32 v49, v32, v32
  v_add_f32 v48, v48, v33
  v_fmac_f32 v49, v33, v33
  v_add_f32 v48, v48, v34
  v_fmac_f32 v49, v34, v34
  v_add_f32 v48, v48, v35
  v_fmac_f32 v49, v35, v35
P3_skip_96:
  v_mov_b32 v5, v48
  s_nop 1
  v_permlane16_swap_b32 v48, v5
  v_add_f32 v48, v48, v5
  v_mov_b32 v5, v48
  s_nop 1
  v_permlane32_swap_b32 v48, v5
  v_add_f32 v48, v48, v5
  v_mov_b32 v5, v49
  s_nop 1
  v_permlane16_swap_b32 v49, v5
  v_add_f32 v49, v49, v5
  v_mov_b32 v5, v49
  s_nop 1
  v_permlane32_swap_b32 v49, v5
  v_add_f32 v49, v49, v5
  s_lshl_b32 s40, s36, 4
  s_lshl_b32 s41, s37, 1
  s_add_u32 s40, s40, s41
  s_add_u32 s40, s40, s39
  s_lshl_b32 s40, s40, 9
  s_lshl_b32 s41, s38, 7
  s_add_u32 s40, s40, s41
  s_add_u32 s40, s40, 13361152
  v_lshlrev_b32 v5, 3, v8
  s_add_u32 s46, s45, 2048
  s_add_u32 s47, s45, 4096
  v_min_u32 v52, 0xfffffffe, v52
  v_min_u32 v53, 0xfffffffe, v53
  v_min_u32 v54, 0xfffffffe, v54
  v_min_u32 v55, 0xfffffffe, v55
  v_min_u32 v56, 0xfffffffe, v56
  v_min_u32 v57, 0xfffffffe, v57
  v_min_u32 v48, 0xfffffffe, v48
  v_min_u32 v49, 0xfffffffe, v49
  s_nop 1
  v_permlane16_swap_b32 v52, v54
  v_permlane16_swap_b32 v53, v55
  v_permlane16_swap_b32 v56, v58
  v_permlane16_swap_b32 v57, v59
  s_mov_b32 s56, 0x0000ffff
  s_mov_b32 s57, 0x0000ffff
  buffer_store_dwordx4 v[52:55], v50, s[4:7], s45 offen sc1
  s_mov_b64 exec, 0xffff
  buffer_store_dwordx2 v[48:49], v5, s[4:7], s40 offen sc1
  s_mov_b64 exec, s[56:57]
  s_cmp_eq_u32 s39, 1
  s_cbranch_scc1 P3_st2_97
  buffer_store_dwordx4 v[56:59], v3, s[4:7], s47 offen sc1
P3_st2_97:
  s_mov_b64 exec, -1
  s_mul_i32 s64, s66, 40960
  s_add_u32 s64, s64, 20701184
  v_lshlrev_b32 v2, 4, v1
  buffer_load_dwordx4 v[96:99], v2, s[4:7], s64 offen sc1
  s_add_u32 s64, s64, 1024
  buffer_load_dwordx4 v[100:103], v2, s[4:7], s64 offen sc1
  s_add_u32 s64, s64, 1024
  buffer_load_dwordx4 v[104:107], v2, s[4:7], s64 offen sc1
  s_add_u32 s64, s64, 1024
  buffer_load_dwordx4 v[108:111], v2, s[4:7], s64 offen sc1
  s_add_u32 s64, s64, 1024
  buffer_load_dwordx4 v[112:115], v2, s[4:7], s64 offen sc1
  s_add_u32 s64, s64, 1024
  buffer_load_dwordx4 v[116:119], v2, s[4:7], s64 offen sc1
  s_add_u32 s64, s64, 1024
  buffer_load_dwordx4 v[120:123], v2, s[4:7], s64 offen sc1
  s_add_u32 s64, s64, 1024
  buffer_load_dwordx4 v[124:127], v2, s[4:7], s64 offen sc1
  s_add_u32 s64, s64, 1024
  buffer_load_dwordx4 v[128:131], v2, s[4:7], s64 offen sc1
  s_add_u32 s64, s64, 1024
  v_lshlrev_b32 v88, 4, v1
  v_and_b32 v2, 15, v1
  v_bfe_u32 v3, v1, 4, 1
  v_cmp_eq_u32 vcc, v2, v3
  v_mov_b32 v4, 0x3f803f80
  v_mov_b32 v5, 0
  v_cndmask_b32 v16, v5, v4, vcc
  v_mov_b32 v17, v16
  v_mov_b32 v18, v16
  v_mov_b32 v19, v16
  v_add_u32 v91, 0x10000, v88
  s_mul_i32 s43, s36, 81920
  s_add_u32 s43, s43, 10739712
  s_lshl_b32 s44, s32, 10
  s_add_u32 s43, s43, s44
  s_lshl_b32 s45, s36, 13
  s_add_u32 s45, s45, 13361152
  v_lshlrev_b32 v7, 3, v1
  s_mul_i32 s68, s37, 276480
  s_lshl_b32 s40, s69, 10
  s_add_u32 s68, s68, s40
  s_add_u32 s68, s68, 23814144
  s_waitcnt vmcnt(0)
  v_mfma_f32_16x16x32_bf16 v[12:15], v[16:19], v[96:99], v[12:15]
  v_mfma_f32_16x16x32_bf16 v[12:15], v[16:19], v[100:103], v[12:15]
  v_mfma_f32_16x16x32_bf16 v[12:15], v[16:19], v[104:107], v[12:15]
  v_mfma_f32_16x16x32_bf16 v[12:15], v[16:19], v[108:111], v[12:15]
  v_mfma_f32_16x16x32_bf16 v[12:15], v[16:19], v[112:115], v[12:15]
  v_mfma_f32_16x16x32_bf16 v[12:15], v[16:19], v[116:119], v[12:15]
  v_mfma_f32_16x16x32_bf16 v[12:15], v[16:19], v[120:123], v[12:15]
  v_mfma_f32_16x16x32_bf16 v[12:15], v[16:19], v[124:127], v[12:15]
  v_mfma_f32_16x16x32_bf16 v[12:15], v[16:19], v[128:131], v[12:15]
  s_lshl_b32 s40, s32, 10
  s_add_u32 s45, s45, s40
  s_add_u32 s40, s43, 0
  buffer_load_dwordx4 v[16:19], v88, s[4:7], s40 offen sc1
  s_add_u32 s40, s43, 8192
  buffer_load_dwordx4 v[20:23], v88, s[4:7], s40 offen sc1
  s_add_u32 s40, s43, 16384
  buffer_load_dwordx4 v[24:27], v88, s[4:7], s40 offen sc1
  s_add_u32 s40, s43, 24576
  buffer_load_dwordx4 v[28:31], v88, s[4:7], s40 offen sc1
  s_add_u32 s40, s43, 32768
  buffer_load_dwordx4 v[32:35], v88, s[4:7], s40 offen sc1
  s_add_u32 s40, s43, 40960
  buffer_load_dwordx4 v[36:39], v88, s[4:7], s40 offen sc1
  s_add_u32 s40, s43, 49152
  buffer_load_dwordx4 v[40:43], v88, s[4:7], s40 offen sc1
  s_add_u32 s40, s43, 57344
  buffer_load_dwordx4 v[44:47], v88, s[4:7], s40 offen sc1
  s_add_u32 s40, s43, 65536
  buffer_load_dwordx4 v[48:51], v88, s[4:7], s40 offen sc1
  s_add_u32 s40, s43, 73728
  buffer_load_dwordx4 v[52:55], v88, s[4:7], s40 offen sc1
  buffer_load_dwordx2 v[80:81], v7, s[4:7], s45 offen sc1
  buffer_load_dwordx2 v[82:83], v7, s[4:7], s45 offen offset:512 sc1
  s_mov_b32 s61, 0
pf_top_98:
  s_waitcnt vmcnt(0)
  s_mov_b32 s62, 0
  v_max3_u32 v3, v16, v17, v18
  v_max_u32 v3, v3, v19
  v_cmp_eq_u32 vcc, -1, v3
  s_cmp_eq_u64 vcc, 0
  s_cbranch_scc1 pf_n_100
  s_mov_b32 s62, 1
  s_add_u32 s40, s43, 0
  buffer_load_dwordx4 v[16:19], v88, s[4:7], s40 offen sc1
pf_n_100:
  v_max3_u32 v3, v20, v21, v22
  v_max_u32 v3, v3, v23
  v_cmp_eq_u32 vcc, -1, v3
  s_cmp_eq_u64 vcc, 0
  s_cbranch_scc1 pf_n_101
  s_mov_b32 s62, 1
  s_add_u32 s40, s43, 8192
  buffer_load_dwordx4 v[20:23], v88, s[4:7], s40 offen sc1
pf_n_101:
  v_max3_u32 v3, v24, v25, v26
  v_max_u32 v3, v3, v27
  v_cmp_eq_u32 vcc, -1, v3
  s_cmp_eq_u64 vcc, 0
  s_cbranch_scc1 pf_n_102
  s_mov_b32 s62, 1
  s_add_u32 s40, s43, 16384
  buffer_load_dwordx4 v[24:27], v88, s[4:7], s40 offen sc1
pf_n_102:
  v_max3_u32 v3, v28, v29, v30
  v_max_u32 v3, v3, v31
  v_cmp_eq_u32 vcc, -1, v3
  s_cmp_eq_u64 vcc, 0
  s_cbranch_scc1 pf_n_103
  s_mov_b32 s62, 1
  s_add_u32 s40, s43, 24576
  buffer_load_dwordx4 v[28:31], v88, s[4:7], s40 offen sc1
pf_n_103:
  v_max3_u32 v3, v32, v33, v34
  v_max_u32 v3, v3, v35
  v_cmp_eq_u32 vcc, -1, v3
  s_cmp_eq_u64 vcc, 0
  s_cbranch_scc1 pf_n_104
  s_mov_b32 s62, 1
  s_add_u32 s40, s43, 32768
  buffer_load_dwordx4 v[32:35], v88, s[4:7], s40 offen sc1
pf_n_104:
  v_max3_u32 v3, v36, v37, v38
  v_max_u32 v3, v3, v39
  v_cmp_eq_u32 vcc, -1, v3
  s_cmp_eq_u64 vcc, 0
  s_cbranch_scc1 pf_n_105
  s_mov_b32 s62, 1
  s_add_u32 s40, s43, 40960
  buffer_load_dwordx4 v[36:39], v88, s[4:7], s40 offen sc1
pf_n_105:
  v_max3_u32 v3, v40, v41, v42
  v_max_u32 v3, v3, v43
  v_cmp_eq_u32 vcc, -1, v3
  s_cmp_eq_u64 vcc, 0
  s_cbranch_scc1 pf_n_106
  s_mov_b32 s62, 1
  s_add_u32 s40, s43, 49152
  buffer_load_dwordx4 v[40:43], v88, s[4:7], s40 offen sc1
pf_n_106:
  v_max3_u32 v3, v44, v45, v46
  v_max_u32 v3, v3, v47
  v_cmp_eq_u32 vcc, -1, v3
  s_cmp_eq_u64 vcc, 0
  s_cbranch_scc1 pf_n_107
  s_mov_b32 s62, 1
  s_add_u32 s40, s43, 57344
  buffer_load_dwordx4 v[44:47], v88, s[4:7], s40 offen sc1
pf_n_107:
  v_max3_u32 v3, v48, v49, v50
  v_max_u32 v3, v3, v51
  v_cmp_eq_u32 vcc, -1, v3
  s_cmp_eq_u64 vcc, 0
  s_cbranch_scc1 pf_n_108
  s_mov_b32 s62, 1
  s_add_u32 s40, s43, 65536
  buffer_load_dwordx4 v[48:51], v88, s[4:7], s40 offen sc1
pf_n_108:
  v_max3_u32 v3, v52, v53, v54
  v_max_u32 v3, v3, v55
  v_cmp_eq_u32 vcc, -1, v3
  s_cmp_eq_u64 vcc, 0
  s_cbranch_scc1 pf_n_109
  s_mov_b32 s62, 1
  s_add_u32 s40, s43, 73728
  buffer_load_dwordx4 v[52:55], v88, s[4:7], s40 offen sc1
pf_n_109:
  v_max3_u32 v3, v80, v81, v82
  v_max_u32 v3, v3, v83
  v_cmp_eq_u32 vcc, -1, v3
  s_cmp_eq_u64 vcc, 0
  s_cbranch_scc1 pf_n_110
  s_mov_b32 s62, 1
  buffer_load_dwordx2 v[80:81], v7, s[4:7], s45 offen sc1
  buffer_load_dwordx2 v[82:83], v7, s[4:7], s45 offen offset:512 sc1
pf_n_110:
  s_cmp_eq_u32 s62, 0
  s_cbranch_scc1 pf_ok_99
  s_add_u32 s61, s61, 1
  s_cmp_lt_u32 s61, 1048576
  s_cbranch_scc1 pf_top_98
  s_waitcnt vmcnt(0)
pf_ok_99:
  v_add_u32 v4, s44, v88
  v_add_u32 v5, 0x10000, v4
  ds_write_b128 v4, v[16:19] offset:0
  ds_write_b128 v4, v[20:23] offset:8192
  ds_write_b128 v4, v[24:27] offset:16384
  ds_write_b128 v4, v[28:31] offset:24576
  ds_write_b128 v4, v[32:35] offset:32768
  ds_write_b128 v4, v[36:39] offset:40960
  ds_write_b128 v4, v[40:43] offset:49152
  ds_write_b128 v4, v[44:47] offset:57344
  ds_write_b128 v5, v[48:51] offset:0
  ds_write_b128 v5, v[52:55] offset:8192
  v_mov_b32 v2, v13
  s_nop 1
  v_permlane16_swap_b32 v12, v2
  s_lshl_b32 s40, s32, 9
  s_add_u32 s40, s40, 81920
  v_add_u32 v84, s40, v7
  v_add_u32 v85, 81920, v7
  v_add_f32 v80, v80, v82
  v_add_f32 v81, v81, v83
  ds_write_b64 v84, v[80:81]
  s_waitcnt lgkmcnt(0)
  s_barrier
  s_lshr_b32 s46, s32, 2
  s_cmp_ge_u32 s32, s67
  s_cbranch_scc1 P4_idle_112
  ds_read_b128 v[48:51], v88 offset:0
  ds_read_b128 v[52:55], v88 offset:1024
  ds_read_b128 v[56:59], v88 offset:2048
  ds_read_b128 v[60:63], v88 offset:3072
  ds_read_b128 v[64:67], v88 offset:4096
  ds_read_b128 v[68:71], v88 offset:5120
  ds_read_b128 v[72:75], v88 offset:6144
  ds_read_b128 v[76:79], v88 offset:7168
  s_waitcnt lgkmcnt(6)
  v_mfma_f32_32x32x16_bf16 v[16:31], v[96:99], v[48:51], 0
  v_mfma_f32_32x32x16_bf16 v[32:47], v[96:99], v[52:55], 0
  ds_read_b128 v[48:51], v88 offset:8192
  ds_read_b128 v[52:55], v88 offset:9216
  s_waitcnt lgkmcnt(6)
  v_mfma_f32_32x32x16_bf16 v[16:31], v[100:103], v[56:59], v[16:31]
  v_mfma_f32_32x32x16_bf16 v[32:47], v[100:103], v[60:63], v[32:47]
  s_mul_i32 s47, s36, 54
  s_add_u32 s47, s47, s66
  s_lshl_b32 s47, s47, 12
  s_add_u32 s47, s47, 13623296
  v_lshrrev_b32 v7, 5, v1
  v_bfe_u32 v3, v1, 4, 1
  v_lshlrev_b32 v3, 10, v3
  v_and_b32 v4, 15, v1
  v_lshl_add_u32 v3, v4, 4, v3
  v_lshl_add_u32 v89, v7, 8, v3
  v_lshlrev_b32 v90, 4, v7
  ds_read_b128 v[56:59], v88 offset:10240
  ds_read_b128 v[60:63], v88 offset:11264
  s_waitcnt lgkmcnt(6)
  v_mfma_f32_32x32x16_bf16 v[16:31], v[104:107], v[64:67], v[16:31]
  v_mfma_f32_32x32x16_bf16 v[32:47], v[104:107], v[68:71], v[32:47]
  ds_read_b128 v[64:67], v88 offset:12288
  ds_read_b128 v[68:71], v88 offset:13312
  s_waitcnt lgkmcnt(6)
  v_mfma_f32_32x32x16_bf16 v[16:31], v[108:111], v[72:75], v[16:31]
  v_mfma_f32_32x32x16_bf16 v[32:47], v[108:111], v[76:79], v[32:47]
  ds_read_b128 v[72:75], v88 offset:14336
  ds_read_b128 v[76:79], v88 offset:15360
  s_waitcnt lgkmcnt(6)
  v_mfma_f32_32x32x16_bf16 v[16:31], v[112:115], v[48:51], v[16:31]
  v_mfma_f32_32x32x16_bf16 v[32:47], v[112:115], v[52:55], v[32:47]
  ds_read_b128 v[48:51], v88 offset:16384
  ds_read_b128 v[52:55], v88 offset:17408
  s_waitcnt lgkmcnt(6)
  v_mfma_f32_32x32x16_bf16 v[16:31], v[116:119], v[56:59], v[16:31]
  v_mfma_f32_32x32x16_bf16 v[32:47], v[116:119], v[60:63], v[32:47]
  ds_read_b128 v[56:59], v88 offset:18432
  ds_read_b128 v[60:63], v88 offset:19456
  s_waitcnt lgkmcnt(6)
  v_mfma_f32_32x32x16_bf16 v[16:31], v[120:123], v[64:67], v[16:31]
  v_mfma_f32_32x32x16_bf16 v[32:47], v[120:123], v[68:71], v[32:47]
  s_cmp_eq_u32 s46, 0
  s_cbranch_scc0 w2s_114
  s_add_u32 s41, s68, 0
  buffer_load_dwordx4 v[116:119], v88, s[4:7], s41 offen sc1
  s_add_u32 s41, s68, 55296
  buffer_load_dwordx4 v[120:123], v88, s[4:7], s41 offen sc1
w2s_114:
  ds_read_b128 v[64:67], v88 offset:20480
  ds_read_b128 v[68:71], v88 offset:21504
  s_waitcnt lgkmcnt(6)
  v_mfma_f32_32x32x16_bf16 v[16:31], v[124:127], v[72:75], v[16:31]
  v_mfma_f32_32x32x16_bf16 v[32:47], v[124:127], v[76:79], v[32:47]
  ds_read_b64 v[96:97], v85 offset:0
  ds_read_b64 v[98:99], v85 offset:512
  ds_read_b64 v[100:101], v85 offset:1024
  ds_read_b64 v[102:103], v85 offset:1536
  ds_read_b64 v[104:105], v85 offset:2048
  ds_read_b64 v[106:107], v85 offset:2560
  ds_read_b64 v[108:109], v85 offset:3072
  ds_read_b64 v[110:111], v85 offset:3584
  s_cmp_eq_u32 s46, 1
  s_cbranch_scc0 w2s_115
  s_add_u32 s41, s68, 0
  buffer_load_dwordx4 v[116:119], v88, s[4:7], s41 offen sc1
  s_add_u32 s41, s68, 55296
  buffer_load_dwordx4 v[120:123], v88, s[4:7], s41 offen sc1
w2s_115:
  ds_read_b128 v[72:75], v88 offset:22528
  ds_read_b128 v[76:79], v88 offset:23552
  s_waitcnt lgkmcnt(6)
  v_mfma_f32_32x32x16_bf16 v[16:31], v[128:131], v[48:51], v[16:31]
  v_mfma_f32_32x32x16_bf16 v[32:47], v[128:131], v[52:55], v[32:47]
  s_cmp_eq_u32 s46, 0
  s_cbranch_scc0 w2s_116
  s_add_u32 s41, s68, 110592
  buffer_load_dwordx4 v[124:127], v88, s[4:7], s41 offen sc1
  s_add_u32 s41, s68, 165888
  buffer_load_dwordx4 v[128:131], v88, s[4:7], s41 offen sc1
w2s_116:
  ds_read_b128 v[48:51], v88 offset:24576
  ds_read_b128 v[52:55], v88 offset:25600
  s_waitcnt lgkmcnt(6)
  v_mfma_f32_32x32x16_bf16 v[16:31], v[132:135], v[56:59], v[16:31]
  v_mfma_f32_32x32x16_bf16 v[32:47], v[132:135], v[60:63], v[32:47]
  s_cmp_eq_u32 s46, 1
  s_cbranch_scc0 w2s_117
  s_add_u32 s41, s68, 110592
  buffer_load_dwordx4 v[124:127], v88, s[4:7], s41 offen sc1
  s_add_u32 s41, s68, 165888
  buffer_load_dwordx4 v[128:131], v88, s[4:7], s41 offen sc1
w2s_117:
  ds_read_b128 v[56:59], v88 offset:26624
  ds_read_b128 v[60:63], v88 offset:27648
  s_waitcnt lgkmcnt(6)
  v_mfma_f32_32x32x16_bf16 v[16:31], v[136:139], v[64:67], v[16:31]
  v_mfma_f32_32x32x16_bf16 v[32:47], v[136:139], v[68:71], v[32:47]
  s_cmp_eq_u32 s46, 0
  s_cbranch_scc0 w2s_118
  s_add_u32 s41, s68, 221184
  buffer_load_dwordx4 v[132:135], v88, s[4:7], s41 offen sc1
  s_add_u32 s41, s68, 1024
  buffer_load_dwordx4 v[136:139], v88, s[4:7], s41 offen sc1
w2s_118:
  ds_read_b128 v[64:67], v88 offset:28672
  ds_read_b128 v[68:71], v88 offset:29696
  s_waitcnt lgkmcnt(6)
  v_mfma_f32_32x32x16_bf16 v[16:31], v[140:143], v[72:75], v[16:31]
  v_mfma_f32_32x32x16_bf16 v[32:47], v[140:143], v[76:79], v[32:47]
  s_waitcnt lgkmcnt(0)
  v_add_f32 v96, v96, v98
  v_add_f32 v97, v97, v99
  v_add_f32 v96, v96, v100
  v_add_f32 v97, v97, v101
  v_add_f32 v96, v96, v102
  v_add_f32 v97, v97, v103
  v_add_f32 v96, v96, v104
  v_add_f32 v97, v97, v105
  v_add_f32 v96, v96, v106
  v_add_f32 v97, v97, v107
  v_add_f32 v96, v96, v108
  v_add_f32 v97, v97, v109
  v_add_f32 v96, v96, v110
  v_add_f32 v97, v97, v111
  v_mul_f32 v96, 0x3acccccd, v96
  v_mul_f32 v97, 0x3acccccd, v97
  v_fma_f32 v97, -v96, v96, v97
  v_max_f32 v97, 0, v97
  v_add_f32 v97, 0x3727c5ac, v97
  v_rsq_f32 v97, v97
  v_mov_b32 v8, v96
  v_mov_b32 v9, v96
  v_mov_b32 v92, v97
  v_mov_b32 v93, v97
  s_nop 1
  v_permlane32_swap_b32 v8, v9
  v_permlane32_swap_b32 v92, v93
  s_cmp_eq_u32 s46, 1
  s_cbranch_scc0 w2s_119
  s_add_u32 s41, s68, 221184
  buffer_load_dwordx4 v[132:135], v88, s[4:7], s41 offen sc1
  s_add_u32 s41, s68, 1024
  buffer_load_dwordx4 v[136:139], v88, s[4:7], s41 offen sc1
w2s_119:
  ds_read_b128 v[72:75], v88 offset:30720
  ds_read_b128 v[76:79], v88 offset:31744
  s_waitcnt lgkmcnt(6)
  v_mfma_f32_32x32x16_bf16 v[16:31], v[144:147], v[48:51], v[16:31]
  v_mfma_f32_32x32x16_bf16 v[32:47], v[144:147], v[52:55], v[32:47]
  s_cmp_eq_u32 s46, 0
  s_cbranch_scc0 w2s_120
  s_add_u32 s41, s68, 56320
  buffer_load_dwordx4 v[140:143], v88, s[4:7], s41 offen sc1
  s_add_u32 s41, s68, 111616
  buffer_load_dwordx4 v[144:147], v88, s[4:7], s41 offen sc1
w2s_120:
  ds_read_b128 v[48:51], v88 offset:32768
  ds_read_b128 v[52:55], v88 offset:33792
  s_waitcnt lgkmcnt(6)
  v_mfma_f32_32x32x16_bf16 v[16:31], v[148:151], v[56:59], v[16:31]
  v_mfma_f32_32x32x16_bf16 v[32:47], v[148:151], v[60:63], v[32:47]
  s_cmp_eq_u32 s46, 1
  s_cbranch_scc0 w2s_121
  s_add_u32 s41, s68, 56320
  buffer_load_dwordx4 v[140:143], v88, s[4:7], s41 offen sc1
  s_add_u32 s41, s68, 111616
  buffer_load_dwordx4 v[144:147], v88, s[4:7], s41 offen sc1
w2s_121:
  ds_read_b128 v[56:59], v88 offset:34816
  ds_read_b128 v[60:63], v88 offset:35840
  s_waitcnt lgkmcnt(6)
  v_mfma_f32_32x32x16_bf16 v[16:31], v[152:155], v[64:67], v[16:31]
  v_mfma_f32_32x32x16_bf16 v[32:47], v[152:155], v[68:71], v[32:47]
  s_cmp_eq_u32 s46, 0
  s_cbranch_scc0 w2s_122
  s_add_u32 s41, s68, 166912
  buffer_load_dwordx4 v[148:151], v88, s[4:7], s41 offen sc1
  s_add_u32 s41, s68, 222208
  buffer_load_dwordx4 v[152:155], v88, s[4:7], s41 offen sc1
w2s_122:
  ds_read_b128 v[64:67], v88 offset:36864
  ds_read_b128 v[68:71], v88 offset:37888
  s_waitcnt lgkmcnt(6)
  v_mfma_f32_32x32x16_bf16 v[16:31], v[156:159], v[72:75], v[16:31]
  v_mfma_f32_32x32x16_bf16 v[32:47], v[156:159], v[76:79], v[32:47]
  ds_bpermute_b32 v96, v90, v12 offset:0
  ds_bpermute_b32 v97, v90, v12 offset:4
  ds_bpermute_b32 v98, v90, v12 offset:8
  ds_bpermute_b32 v99, v90, v12 offset:12
  ds_bpermute_b32 v100, v90, v12 offset:32
  ds_bpermute_b32 v101, v90, v12 offset:36
  ds_bpermute_b32 v102, v90, v12 offset:40
  ds_bpermute_b32 v103, v90, v12 offset:44
  ds_bpermute_b32 v104, v90, v12 offset:64
  ds_bpermute_b32 v105, v90, v12 offset:68
  ds_bpermute_b32 v106, v90, v12 offset:72
  ds_bpermute_b32 v107, v90, v12 offset:76
  ds_bpermute_b32 v108, v90, v12 offset:96
  ds_bpermute_b32 v109, v90, v12 offset:100
  ds_bpermute_b32 v110, v90, v12 offset:104
  ds_bpermute_b32 v111, v90, v12 offset:108
  s_cmp_eq_u32 s46, 1
  s_cbranch_scc0 w2s_123
  s_add_u32 s41, s68, 166912
  buffer_load_dwordx4 v[148:151], v88, s[4:7], s41 offen sc1
  s_add_u32 s41, s68, 222208
  buffer_load_dwordx4 v[152:155], v88, s[4:7], s41 offen sc1
w2s_123:
  ds_read_b128 v[72:75], v88 offset:38912
  ds_read_b128 v[76:79], v88 offset:39936
  s_waitcnt lgkmcnt(6)
  v_mfma_f32_32x32x16_bf16 v[16:31], v[160:163], v[48:51], v[16:31]
  v_mfma_f32_32x32x16_bf16 v[32:47], v[160:163], v[52:55], v[32:47]
  s_cmp_eq_u32 s46, 0
  s_cbranch_scc0 w2s_124
  s_add_u32 s41, s68, 2048
  buffer_load_dwordx4 v[156:159], v88, s[4:7], s41 offen sc1
  s_add_u32 s41, s68, 57344
  buffer_load_dwordx4 v[160:163], v88, s[4:7], s41 offen sc1
w2s_124:
  ds_read_b128 v[48:51], v88 offset:40960
  ds_read_b128 v[52:55], v88 offset:41984
  s_waitcnt lgkmcnt(6)
  v_mfma_f32_32x32x16_bf16 v[16:31], v[164:167], v[56:59], v[16:31]
  v_mfma_f32_32x32x16_bf16 v[32:47], v[164:167], v[60:63], v[32:47]
  s_cmp_eq_u32 s46, 1
  s_cbranch_scc0 w2s_125
  s_add_u32 s41, s68, 2048
  buffer_load_dwordx4 v[156:159], v88, s[4:7], s41 offen sc1
  s_add_u32 s41, s68, 57344
  buffer_load_dwordx4 v[160:163], v88, s[4:7], s41 offen sc1
w2s_125:
  ds_read_b128 v[56:59], v88 offset:43008
  ds_read_b128 v[60:63], v88 offset:44032
  s_waitcnt lgkmcnt(6)
  v_mfma_f32_32x32x16_bf16 v[16:31], v[168:171], v[64:67], v[16:31]
  v_mfma_f32_32x32x16_bf16 v[32:47], v[168:171], v[68:71], v[32:47]
  s_cmp_eq_u32 s46, 0
  s_cbranch_scc0 w2s_126
  s_add_u32 s41, s68, 112640
  buffer_load_dwordx4 v[164:167], v88, s[4:7], s41 offen sc1
  s_add_u32 s41, s68, 167936
  buffer_load_dwordx4 v[168:171], v88, s[4:7], s41 offen sc1
w2s_126:
  ds_read_b128 v[64:67], v88 offset:45056
  ds_read_b128 v[68:71], v88 offset:46080
  s_waitcnt lgkmcnt(6)
  v_mfma_f32_32x32x16_bf16 v[16:31], v[172:175], v[72:75], v[16:31]
  v_mfma_f32_32x32x16_bf16 v[32:47], v[172:175], v[76:79], v[32:47]
  s_cmp_eq_u32 s46, 1
  s_cbranch_scc0 w2s_127
  s_add_u32 s41, s68, 112640
  buffer_load_dwordx4 v[164:167], v88, s[4:7], s41 offen sc1
  s_add_u32 s41, s68, 167936
  buffer_load_dwordx4 v[168:171], v88, s[4:7], s41 offen sc1
w2s_127:
  ds_read_b128 v[72:75], v88 offset:47104
  ds_read_b128 v[76:79], v88 offset:48128
  s_waitcnt lgkmcnt(6)
  v_mfma_f32_32x32x16_bf16 v[16:31], v[176:179], v[48:51], v[16:31]
  v_mfma_f32_32x32x16_bf16 v[32:47], v[176:179], v[52:55], v[32:47]
  s_cmp_eq_u32 s46, 0
  s_cbranch_scc0 w2s_128
  s_add_u32 s41, s68, 223232
  buffer_load_dwordx4 v[172:175], v88, s[4:7], s41 offen sc1
  s_add_u32 s41, s68, 3072
  buffer_load_dwordx4 v[176:179], v88, s[4:7], s41 offen sc1
w2s_128:
  ds_read_b128 v[48:51], v88 offset:49152
  ds_read_b128 v[52:55], v88 offset:50176
  s_waitcnt lgkmcnt(6)
  v_mfma_f32_32x32x16_bf16 v[16:31], v[180:183], v[56:59], v[16:31]
  v_mfma_f32_32x32x16_bf16 v[32:47], v[180:183], v[60:63], v[32:47]
  s_cmp_eq_u32 s46, 1
  s_cbranch_scc0 w2s_129
  s_add_u32 s41, s68, 223232
  buffer_load_dwordx4 v[172:175], v88, s[4:7], s41 offen sc1
  s_add_u32 s41, s68, 3072
  buffer_load_dwordx4 v[176:179], v88, s[4:7], s41 offen sc1
w2s_129:
  ds_read_b128 v[56:59], v88 offset:51200
  ds_read_b128 v[60:63], v88 offset:52224
  s_waitcnt lgkmcnt(6)
  v_mfma_f32_32x32x16_bf16 v[16:31], v[184:187], v[64:67], v[16:31]
  v_mfma_f32_32x32x16_bf16 v[32:47], v[184:187], v[68:71], v[32:47]
  s_cmp_eq_u32 s46, 0
  s_cbranch_scc0 w2s_130
  s_add_u32 s41, s68, 58368
  buffer_load_dwordx4 v[180:183], v88, s[4:7], s41 offen sc1
  s_add_u32 s41, s68, 113664
  buffer_load_dwordx4 v[184:187], v88, s[4:7], s41 offen sc1
w2s_130:
  ds_read_b128 v[64:67], v88 offset:53248
  ds_read_b128 v[68:71], v88 offset:54272
  s_waitcnt lgkmcnt(6)
  v_mfma_f32_32x32x16_bf16 v[16:31], v[188:191], v[72:75], v[16:31]
  v_mfma_f32_32x32x16_bf16 v[32:47], v[188:191], v[76:79], v[32:47]
  s_cmp_eq_u32 s46, 1
  s_cbranch_scc0 w2s_131
  s_add_u32 s41, s68, 58368
  buffer_load_dwordx4 v[180:183], v88, s[4:7], s41 offen sc1
  s_add_u32 s41, s68, 113664
  buffer_load_dwordx4 v[184:187], v88, s[4:7], s41 offen sc1
w2s_131:
  ds_read_b128 v[72:75], v88 offset:55296
  ds_read_b128 v[76:79], v88 offset:56320
  s_waitcnt lgkmcnt(6)
  v_mfma_f32_32x32x16_bf16 v[16:31], v[192:195], v[48:51], v[16:31]
  v_mfma_f32_32x32x16_bf16 v[32:47], v[192:195], v[52:55], v[32:47]
  s_cmp_eq_u32 s46, 0
  s_cbranch_scc0 w2s_132
  s_add_u32 s41, s68, 168960
  buffer_load_dwordx4 v[188:191], v88, s[4:7], s41 offen sc1
  s_add_u32 s41, s68, 224256
  buffer_load_dwordx4 v[192:195], v88, s[4:7], s41 offen sc1
w2s_132:
  ds_read_b128 v[48:51], v88 offset:57344
  ds_read_b128 v[52:55], v88 offset:58368
  s_waitcnt lgkmcnt(6)
  v_mfma_f32_32x32x16_bf16 v[16:31], v[196:199], v[56:59], v[16:31]
  v_mfma_f32_32x32x16_bf16 v[32:47], v[196:199], v[60:63], v[32:47]
  s_cmp_eq_u32 s46, 1
  s_cbranch_scc0 w2s_133
  s_add_u32 s41, s68, 168960
  buffer_load_dwordx4 v[188:191], v88, s[4:7], s41 offen sc1
  s_add_u32 s41, s68, 224256
  buffer_load_dwordx4 v[192:195], v88, s[4:7], s41 offen sc1
w2s_133:
  ds_read_b128 v[56:59], v88 offset:59392
  ds_read_b128 v[60:63], v88 offset:60416
  s_waitcnt lgkmcnt(6)
  v_mfma_f32_32x32x16_bf16 v[16:31], v[200:203], v[64:67], v[16:31]
  v_mfma_f32_32x32x16_bf16 v[32:47], v[200:203], v[68:71], v[32:47]
  s_cmp_eq_u32 s46, 0
  s_cbranch_scc0 w2s_134
  s_add_u32 s41, s68, 4096
  buffer_load_dwordx4 v[196:199], v88, s[4:7], s41 offen sc1
  s_add_u32 s41, s68, 59392
  buffer_load_dwordx4 v[200:203], v88, s[4:7], s41 offen sc1
w2s_134:
  ds_read_b128 v[64:67], v88 offset:61440
  ds_read_b128 v[68:71], v88 offset:62464
  s_waitcnt lgkmcnt(6)
  v_mfma_f32_32x32x16_bf16 v[16:31], v[204:207], v[72:75], v[16:31]
  v_mfma_f32_32x32x16_bf16 v[32:47], v[204:207], v[76:79], v[32:47]
  s_cmp_eq_u32 s46, 1
  s_cbranch_scc0 w2s_135
  s_add_u32 s41, s68, 4096
  buffer_load_dwordx4 v[196:199], v88, s[4:7], s41 offen sc1
  s_add_u32 s41, s68, 59392
  buffer_load_dwordx4 v[200:203], v88, s[4:7], s41 offen sc1
w2s_135:
  ds_read_b128 v[72:75], v88 offset:63488
  ds_read_b128 v[76:79], v88 offset:64512
  s_waitcnt lgkmcnt(6)
  v_mfma_f32_32x32x16_bf16 v[16:31], v[208:211], v[48:51], v[16:31]
  v_mfma_f32_32x32x16_bf16 v[32:47], v[208:211], v[52:55], v[32:47]
  s_cmp_eq_u32 s46, 0
  s_cbranch_scc0 w2s_136
  s_add_u32 s41, s68, 114688
  buffer_load_dwordx4 v[204:207], v88, s[4:7], s41 offen sc1
  s_add_u32 s41, s68, 169984
  buffer_load_dwordx4 v[208:211], v88, s[4:7], s41 offen sc1
w2s_136:
  ds_read_b128 v[48:51], v91 offset:0
  ds_read_b128 v[52:55], v91 offset:1024
  s_waitcnt lgkmcnt(6)
  v_mfma_f32_32x32x16_bf16 v[16:31], v[212:215], v[56:59], v[16:31]
  v_mfma_f32_32x32x16_bf16 v[32:47], v[212:215], v[60:63], v[32:47]
  s_cmp_eq_u32 s46, 1
  s_cbranch_scc0 w2s_137
  s_add_u32 s41, s68, 114688
  buffer_load_dwordx4 v[204:207], v88, s[4:7], s41 offen sc1
  s_add_u32 s41, s68, 169984
  buffer_load_dwordx4 v[208:211], v88, s[4:7], s41 offen sc1
w2s_137:
  ds_read_b128 v[56:59], v91 offset:2048
  ds_read_b128 v[60:63], v91 offset:3072
  s_waitcnt lgkmcnt(6)
  v_mfma_f32_32x32x16_bf16 v[16:31], v[216:219], v[64:67], v[16:31]
  v_mfma_f32_32x32x16_bf16 v[32:47], v[216:219], v[68:71], v[32:47]
  s_cmp_eq_u32 s46, 0
  s_cbranch_scc0 w2s_138
  s_add_u32 s41, s68, 225280
  buffer_load_dwordx4 v[212:215], v88, s[4:7], s41 offen sc1
  s_add_u32 s41, s68, 5120
  buffer_load_dwordx4 v[216:219], v88, s[4:7], s41 offen sc1
w2s_138:
  ds_read_b128 v[64:67], v91 offset:4096
  ds_read_b128 v[68:71], v91 offset:5120
  s_waitcnt lgkmcnt(6)
  v_mfma_f32_32x32x16_bf16 v[16:31], v[220:223], v[72:75], v[16:31]
  v_mfma_f32_32x32x16_bf16 v[32:47], v[220:223], v[76:79], v[32:47]
  s_cmp_eq_u32 s46, 1
  s_cbranch_scc0 w2s_139
  s_add_u32 s41, s68, 225280
  buffer_load_dwordx4 v[212:215], v88, s[4:7], s41 offen sc1
  s_add_u32 s41, s68, 5120
  buffer_load_dwordx4 v[216:219], v88, s[4:7], s41 offen sc1
w2s_139:
  ds_read_b128 v[72:75], v91 offset:6144
  ds_read_b128 v[76:79], v91 offset:7168
  s_waitcnt lgkmcnt(6)
  v_mfma_f32_32x32x16_bf16 v[16:31], v[224:227], v[48:51], v[16:31]
  v_mfma_f32_32x32x16_bf16 v[32:47], v[224:227], v[52:55], v[32:47]
  s_cmp_eq_u32 s46, 0
  s_cbranch_scc0 w2s_140
  s_add_u32 s41, s68, 60416
  buffer_load_dwordx4 v[220:223], v88, s[4:7], s41 offen sc1
  s_add_u32 s41, s68, 115712
  buffer_load_dwordx4 v[224:227], v88, s[4:7], s41 offen sc1
w2s_140:
  ds_read_b128 v[48:51], v91 offset:8192
  ds_read_b128 v[52:55], v91 offset:9216
  s_waitcnt lgkmcnt(6)
  v_mfma_f32_32x32x16_bf16 v[16:31], v[228:231], v[56:59], v[16:31]
  v_mfma_f32_32x32x16_bf16 v[32:47], v[228:231], v[60:63], v[32:47]
  s_cmp_eq_u32 s46, 1
  s_cbranch_scc0 w2s_141
  s_add_u32 s41, s68, 60416
  buffer_load_dwordx4 v[220:223], v88, s[4:7], s41 offen sc1
  s_add_u32 s41, s68, 115712
  buffer_load_dwordx4 v[224:227], v88, s[4:7], s41 offen sc1
w2s_141:
  ds_read_b128 v[56:59], v91 offset:10240
  ds_read_b128 v[60:63], v91 offset:11264
  s_waitcnt lgkmcnt(6)
  v_mfma_f32_32x32x16_bf16 v[16:31], v[232:235], v[64:67], v[16:31]
  v_mfma_f32_32x32x16_bf16 v[32:47], v[232:235], v[68:71], v[32:47]
  s_cmp_eq_u32 s46, 0
  s_cbranch_scc0 w2s_142
  s_add_u32 s41, s68, 171008
  buffer_load_dwordx4 v[228:231], v88, s[4:7], s41 offen sc1
  s_add_u32 s41, s68, 226304
  buffer_load_dwordx4 v[232:235], v88, s[4:7], s41 offen sc1
w2s_142:
  ds_read_b128 v[64:67], v91 offset:12288
  ds_read_b128 v[68:71], v91 offset:13312
  s_waitcnt lgkmcnt(6)
  v_mfma_f32_32x32x16_bf16 v[16:31], v[236:239], v[72:75], v[16:31]
  v_mfma_f32_32x32x16_bf16 v[32:47], v[236:239], v[76:79], v[32:47]
  s_cmp_eq_u32 s46, 1
  s_cbranch_scc0 w2s_143
  s_add_u32 s41, s68, 171008
  buffer_load_dwordx4 v[228:231], v88, s[4:7], s41 offen sc1
  s_add_u32 s41, s68, 226304
  buffer_load_dwordx4 v[232:235], v88, s[4:7], s41 offen sc1
w2s_143:
  ds_read_b128 v[72:75], v91 offset:14336
  ds_read_b128 v[76:79], v91 offset:15360
  s_waitcnt lgkmcnt(6)
  v_mfma_f32_32x32x16_bf16 v[16:31], v[240:243], v[48:51], v[16:31]
  v_mfma_f32_32x32x16_bf16 v[32:47], v[240:243], v[52:55], v[32:47]
  s_waitcnt lgkmcnt(4)
  v_mfma_f32_32x32x16_bf16 v[16:31], v[244:247], v[56:59], v[16:31]
  v_mfma_f32_32x32x16_bf16 v[32:47], v[244:247], v[60:63], v[32:47]
  s_waitcnt lgkmcnt(2)
  v_mfma_f32_32x32x16_bf16 v[16:31], v[248:251], v[64:67], v[16:31]
  v_mfma_f32_32x32x16_bf16 v[32:47], v[248:251], v[68:71], v[32:47]
  s_waitcnt lgkmcnt(0)
  v_mfma_f32_32x32x16_bf16 v[16:31], v[252:255], v[72:75], v[16:31]
  v_mfma_f32_32x32x16_bf16 v[32:47], v[252:255], v[76:79], v[32:47]
  s_branch P4_join_113
P4_idle_112:
  s_add_u32 s41, s68, 0
  buffer_load_dwordx4 v[116:119], v88, s[4:7], s41 offen sc1
  s_add_u32 s41, s68, 55296
  buffer_load_dwordx4 v[120:123], v88, s[4:7], s41 offen sc1
  s_add_u32 s41, s68, 110592
  buffer_load_dwordx4 v[124:127], v88, s[4:7], s41 offen sc1
  s_add_u32 s41, s68, 165888
  buffer_load_dwordx4 v[128:131], v88, s[4:7], s41 offen sc1
  s_add_u32 s41, s68, 221184
  buffer_load_dwordx4 v[132:135], v88, s[4:7], s41 offen sc1
  s_add_u32 s41, s68, 1024
  buffer_load_dwordx4 v[136:139], v88, s[4:7], s41 offen sc1
  s_add_u32 s41, s68, 56320
  buffer_load_dwordx4 v[140:143], v88, s[4:7], s41 offen sc1
  s_add_u32 s41, s68, 111616
  buffer_load_dwordx4 v[144:147], v88, s[4:7], s41 offen sc1
  s_add_u32 s41, s68, 166912
  buffer_load_dwordx4 v[148:151], v88, s[4:7], s41 offen sc1
  s_add_u32 s41, s68, 222208
  buffer_load_dwordx4 v[152:155], v88, s[4:7], s41 offen sc1
  s_add_u32 s41, s68, 2048
  buffer_load_dwordx4 v[156:159], v88, s[4:7], s41 offen sc1
  s_add_u32 s41, s68, 57344
  buffer_load_dwordx4 v[160:163], v88, s[4:7], s41 offen sc1
  s_add_u32 s41, s68, 112640
  buffer_load_dwordx4 v[164:167], v88, s[4:7], s41 offen sc1
  s_add_u32 s41, s68, 167936
  buffer_load_dwordx4 v[168:171], v88, s[4:7], s41 offen sc1
  s_add_u32 s41, s68, 223232
  buffer_load_dwordx4 v[172:175], v88, s[4:7], s41 offen sc1
  s_add_u32 s41, s68, 3072
  buffer_load_dwordx4 v[176:179], v88, s[4:7], s41 offen sc1
  s_add_u32 s41, s68, 58368
  buffer_load_dwordx4 v[180:183], v88, s[4:7], s41 offen sc1
  s_add_u32 s41, s68, 113664
  buffer_load_dwordx4 v[184:187], v88, s[4:7], s41 offen sc1
  s_add_u32 s41, s68, 168960
  buffer_load_dwordx4 v[188:191], v88, s[4:7], s41 offen sc1
  s_add_u32 s41, s68, 224256
  buffer_load_dwordx4 v[192:195], v88, s[4:7], s41 offen sc1
  s_add_u32 s41, s68, 4096
  buffer_load_dwordx4 v[196:199], v88, s[4:7], s41 offen sc1
  s_add_u32 s41, s68, 59392
  buffer_load_dwordx4 v[200:203], v88, s[4:7], s41 offen sc1
  s_add_u32 s41, s68, 114688
  buffer_load_dwordx4 v[204:207], v88, s[4:7], s41 offen sc1
  s_add_u32 s41, s68, 169984
  buffer_load_dwordx4 v[208:211], v88, s[4:7], s41 offen sc1
  s_add_u32 s41, s68, 225280
  buffer_load_dwordx4 v[212:215], v88, s[4:7], s41 offen sc1
  s_add_u32 s41, s68, 5120
  buffer_load_dwordx4 v[216:219], v88, s[4:7], s41 offen sc1
  s_add_u32 s41, s68, 60416
  buffer_load_dwordx4 v[220:223], v88, s[4:7], s41 offen sc1
  s_add_u32 s41, s68, 115712
  buffer_load_dwordx4 v[224:227], v88, s[4:7], s41 offen sc1
  s_add_u32 s41, s68, 171008
  buffer_load_dwordx4 v[228:231], v88, s[4:7], s41 offen sc1
  s_add_u32 s41, s68, 226304
  buffer_load_dwordx4 v[232:235], v88, s[4:7], s41 offen sc1
P4_join_113:
  s_cmp_eq_u32 s70, 6
  s_cbranch_scc1 P4_no7_144
  s_add_u32 s41, s68, 6144
  buffer_load_dwordx4 v[236:239], v88, s[4:7], s41 offen sc1
  s_add_u32 s41, s68, 61440
  buffer_load_dwordx4 v[240:243], v88, s[4:7], s41 offen sc1
  s_add_u32 s41, s68, 116736
  buffer_load_dwordx4 v[244:247], v88, s[4:7], s41 offen sc1
  s_add_u32 s41, s68, 172032
  buffer_load_dwordx4 v[248:251], v88, s[4:7], s41 offen sc1
  s_add_u32 s41, s68, 227328
  buffer_load_dwordx4 v[252:255], v88, s[4:7], s41 offen sc1
  s_branch P4_no7e_145
P4_no7_144:
  v_mov_b32 v236, 0
  v_mov_b32 v237, 0
  v_mov_b32 v238, 0
  v_mov_b32 v239, 0
  v_mov_b32 v240, 0
  v_mov_b32 v241, 0
  v_mov_b32 v242, 0
  v_mov_b32 v243, 0
  v_mov_b32 v244, 0
  v_mov_b32 v245, 0
  v_mov_b32 v246, 0
  v_mov_b32 v247, 0
  v_mov_b32 v248, 0
  v_mov_b32 v249, 0
  v_mov_b32 v250, 0
  v_mov_b32 v251, 0
  v_mov_b32 v252, 0
  v_mov_b32 v253, 0
  v_mov_b32 v254, 0
  v_mov_b32 v255, 0
P4_no7e_145:
  s_cmp_ge_u32 s32, s67
  s_cbranch_scc1 P4_skip_111
  v_sub_f32 v48, 0, v8
  v_sub_f32 v49, 0, v8
  v_sub_f32 v50, 0, v9
  v_sub_f32 v51, 0, v9
  v_mov_b32 v52, v92
  v_mov_b32 v53, v92
  v_mov_b32 v54, v93
  v_mov_b32 v55, v93
  v_pk_fma_f32 v[16:17], v[48:49], v[96:97], v[16:17]
  v_pk_fma_f32 v[18:19], v[48:49], v[98:99], v[18:19]
  v_pk_fma_f32 v[20:21], v[48:49], v[100:101], v[20:21]
  v_pk_fma_f32 v[22:23], v[48:49], v[102:103], v[22:23]
  v_pk_fma_f32 v[24:25], v[48:49], v[104:105], v[24:25]
  v_pk_fma_f32 v[26:27], v[48:49], v[106:107], v[26:27]
  v_pk_fma_f32 v[28:29], v[48:49], v[108:109], v[28:29]
  v_pk_fma_f32 v[30:31], v[48:49], v[110:111], v[30:31]
  v_pk_mul_f32 v[16:17], v[52:53], v[16:17]
  v_pk_mul_f32 v[18:19], v[52:53], v[18:19]
  v_pk_mul_f32 v[20:21], v[52:53], v[20:21]
  v_pk_mul_f32 v[22:23], v[52:53], v[22:23]
  v_pk_mul_f32 v[24:25], v[52:53], v[24:25]
  v_pk_mul_f32 v[26:27], v[52:53], v[26:27]
  v_pk_mul_f32 v[28:29], v[52:53], v[28:29]
  v_pk_mul_f32 v[30:31], v[52:53], v[30:31]
  v_cvt_pk_bf16_f32 v64, v16, v17
  v_cvt_pk_bf16_f32 v65, v18, v19
  v_cvt_pk_bf16_f32 v66, v20, v21
  v_cvt_pk_bf16_f32 v67, v22, v23
  v_cvt_pk_bf16_f32 v68, v24, v25
  v_cvt_pk_bf16_f32 v69, v26, v27
  v_cvt_pk_bf16_f32 v70, v28, v29
  v_cvt_pk_bf16_f32 v71, v30, v31
  v_pk_fma_f32 v[32:33], v[50:51], v[96:97], v[32:33]
  v_pk_fma_f32 v[34:35], v[50:51], v[98:99], v[34:35]
  v_pk_fma_f32 v[36:37], v[50:51], v[100:101], v[36:37]
  v_pk_fma_f32 v[38:39], v[50:51], v[102:103], v[38:39]
  v_pk_fma_f32 v[40:41], v[50:51], v[104:105], v[40:41]
  v_pk_fma_f32 v[42:43], v[50:51], v[106:107], v[42:43]
  v_pk_fma_f32 v[44:45], v[50:51], v[108:109], v[44:45]
  v_pk_fma_f32 v[46:47], v[50:51], v[110:111], v[46:47]
  v_pk_mul_f32 v[32:33], v[54:55], v[32:33]
  v_pk_mul_f32 v[34:35], v[54:55], v[34:35]
  v_pk_mul_f32 v[36:37], v[54:55], v[36:37]
  v_pk_mul_f32 v[38:39], v[54:55], v[38:39]
  v_pk_mul_f32 v[40:41], v[54:55], v[40:41]
  v_pk_mul_f32 v[42:43], v[54:55], v[42:43]
  v_pk_mul_f32 v[44:45], v[54:55], v[44:45]
  v_pk_mul_f32 v[46:47], v[54:55], v[46:47]
  v_cvt_pk_bf16_f32 v72, v32, v33
  v_cvt_pk_bf16_f32 v73, v34, v35
  v_cvt_pk_bf16_f32 v74, v36, v37
  v_cvt_pk_bf16_f32 v75, v38, v39
  v_cvt_pk_bf16_f32 v76, v40, v41
  v_cvt_pk_bf16_f32 v77, v42, v43
  v_cvt_pk_bf16_f32 v78, v44, v45
  v_cvt_pk_bf16_f32 v79, v46, v47
  v_pk_max_i16 v64, v64, 0
  v_pk_max_i16 v65, v65, 0
  v_pk_max_i16 v66, v66, 0
  v_pk_max_i16 v67, v67, 0
  v_pk_max_i16 v68, v68, 0
  v_pk_max_i16 v69, v69, 0
  v_pk_max_i16 v70, v70, 0
  v_pk_max_i16 v71, v71, 0
  v_pk_max_i16 v72, v72, 0
  v_pk_max_i16 v73, v73, 0
  v_pk_max_i16 v74, v74, 0
  v_pk_max_i16 v75, v75, 0
  v_pk_max_i16 v76, v76, 0
  v_pk_max_i16 v77, v77, 0
  v_pk_max_i16 v78, v78, 0
  v_pk_max_i16 v79, v79, 0
  s_nop 1
  v_permlane32_swap_b32 v64, v66
  v_permlane32_swap_b32 v65, v67
  v_permlane32_swap_b32 v68, v70
  v_permlane32_swap_b32 v69, v71
  v_permlane32_swap_b32 v72, v74
  v_permlane32_swap_b32 v73, v75
  v_permlane32_swap_b32 v76, v78
  v_permlane32_swap_b32 v77, v79
  buffer_store_dwordx4 v[64:67], v89, s[4:7], s47 offen offset:0 sc1
  buffer_store_dwordx4 v[68:71], v89, s[4:7], s47 offen offset:512 sc1
  buffer_store_dwordx4 v[72:75], v89, s[4:7], s47 offen offset:2048 sc1
  buffer_store_dwordx4 v[76:79], v89, s[4:7], s47 offen offset:2560 sc1
P4_skip_111:
  s_waitcnt lgkmcnt(0)
  v_lshlrev_b32 v112, 4, v1
  s_mul_i32 s44, s36, 54
  s_add_u32 s44, s44, s69
  s_lshl_b32 s44, s44, 12
  s_add_u32 s44, s44, 13623296
  s_sub_u32 s45, s70, 1
  s_lshl_b32 s45, s45, 12
  v_and_b32 v8, 15, v1
  v_lshrrev_b32 v9, 4, v1
  s_mul_i32 s47, s36, 40
  s_mul_i32 s41, s37, 5
  s_add_u32 s47, s47, s41
  s_add_u32 s47, s47, s32
  s_lshl_b32 s47, s47, 11
  s_add_u32 s47, s47, 10739712
  v_lshrrev_b32 v3, 1, v9
  v_lshlrev_b32 v3, 9, v3
  v_lshl_add_u32 v3, v8, 4, v3
  v_and_b32 v4, 1, v9
  v_lshl_add_u32 v113, v4, 3, v3
  s_lshl_b32 s48, s36, 6
  s_mul_i32 s48, s48, 1280
  s_mul_i32 s41, s37, 160
  s_add_u32 s48, s48, s41
  s_lshl_b32 s41, s32, 5
  s_add_u32 s48, s48, s41
  v_mul_u32_u24 v3, 1280, v8
  v_lshl_add_u32 v7, v9, 3, v3
  s_mul_i32 s49, s32, 5120
  s_add_u32 s41, s47, 0
  buffer_load_dwordx2 v[10:11], v113, s[4:7], s41 offen sc1
  s_add_u32 s41, s47, 256
  buffer_load_dwordx2 v[12:13], v113, s[4:7], s41 offen sc1
  s_add_u32 s41, s47, 1024
  buffer_load_dwordx2 v[14:15], v113, s[4:7], s41 offen sc1
  s_add_u32 s41, s47, 1280
  buffer_load_dwordx2 v[114:115], v113, s[4:7], s41 offen sc1
  s_barrier
  s_cmp_ge_u32 s32, 5
  s_cselect_b32 s50, 5, 0
  s_sub_u32 s50, s32, s50
  s_lshl_b32 s50, s50, 10
  s_mul_i32 s51, s32, 7168
  s_add_u32 s51, s51, 81920
  v_add_u32 v8, s51, v112
  s_mov_b32 s61, 0
pl_top_146:
  s_add_u32 s41, s44, 0
  buffer_load_dwordx4 v[16:19], v112, s[4:7], s41 offen sc1
  s_add_u32 s41, s44, 4096
  buffer_load_dwordx4 v[20:23], v112, s[4:7], s41 offen sc1
  s_add_u32 s41, s44, 8192
  buffer_load_dwordx4 v[24:27], v112, s[4:7], s41 offen sc1
  s_add_u32 s41, s44, 12288
  buffer_load_dwordx4 v[28:31], v112, s[4:7], s41 offen sc1
  s_add_u32 s41, s44, 16384
  buffer_load_dwordx4 v[32:35], v112, s[4:7], s41 offen sc1
  s_add_u32 s41, s44, 20480
  buffer_load_dwordx4 v[36:39], v112, s[4:7], s41 offen sc1
  s_add_u32 s41, s44, s45
  s_add_u32 s41, s41, 0
  buffer_load_dwordx4 v[40:43], v112, s[4:7], s41 offen sc1
pl_chk_147:
  s_waitcnt vmcnt(0)
  v_max3_u32 v3, v16, v17, v18
  v_max3_u32 v3, v3, v19, v20
  v_max3_u32 v3, v3, v21, v22
  v_max3_u32 v3, v3, v23, v24
  v_max3_u32 v3, v3, v25, v26
  v_max3_u32 v3, v3, v27, v28
  v_max3_u32 v3, v3, v29, v30
  v_max3_u32 v3, v3, v31, v32
  v_max3_u32 v3, v3, v33, v34
  v_max3_u32 v3, v3, v35, v36
  v_max3_u32 v3, v3, v37, v38
  v_max3_u32 v3, v3, v39, v40
  v_max3_u32 v3, v3, v41, v42
  v_max_u32 v3, v3, v43
  v_cmp_eq_u32 vcc, -1, v3
  s_cmp_eq_u64 vcc, 0
  s_cbranch_scc1 pl_ok_148
  s_add_u32 s61, s61, 1
  s_cmp_lt_u32 s61, 1048576
  s_sleep 1
  s_cbranch_scc1 pl_top_146
pl_ok_148:
  s_add_u32 s41, s44, 1024
  buffer_load_dwordx4 v[44:47], v112, s[4:7], s41 offen sc1
  s_add_u32 s41, s44, 5120
  buffer_load_dwordx4 v[48:51], v112, s[4:7], s41 offen sc1
  s_add_u32 s41, s44, 9216
  buffer_load_dwordx4 v[52:55], v112, s[4:7], s41 offen sc1
  s_add_u32 s41, s44, 13312
  buffer_load_dwordx4 v[56:59], v112, s[4:7], s41 offen sc1
  s_add_u32 s41, s44, 17408
  buffer_load_dwordx4 v[60:63], v112, s[4:7], s41 offen sc1
  s_add_u32 s41, s44, 21504
  buffer_load_dwordx4 v[64:67], v112, s[4:7], s41 offen sc1
  s_add_u32 s41, s44, s45
  s_add_u32 s41, s41, 1024
  buffer_load_dwordx4 v[68:71], v112, s[4:7], s41 offen sc1
  s_add_u32 s41, s44, 2048
  s_add_u32 m0, s51, 0
  s_nop 0
  buffer_load_dwordx4 v112, s[4:7], s41 offen sc1 lds
  s_add_u32 s41, s44, 6144
  s_add_u32 m0, s51, 1024
  s_nop 0
  buffer_load_dwordx4 v112, s[4:7], s41 offen sc1 lds
  s_add_u32 s41, s44, 10240
  s_add_u32 m0, s51, 2048
  s_nop 0
  buffer_load_dwordx4 v112, s[4:7], s41 offen sc1 lds
  s_add_u32 s41, s44, 14336
  s_add_u32 m0, s51, 3072
  s_nop 0
  buffer_load_dwordx4 v112, s[4:7], s41 offen sc1 lds
  s_add_u32 s41, s44, 18432
  s_add_u32 m0, s51, 4096
  s_nop 0
  buffer_load_dwordx4 v112, s[4:7], s41 offen sc1 lds
  s_add_u32 s41, s44, 22528
  s_add_u32 m0, s51, 5120
  s_nop 0
  buffer_load_dwordx4 v112, s[4:7], s41 offen sc1 lds
  s_add_u32 s41, s44, s45
  s_add_u32 s41, s41, 2048
  s_add_u32 m0, s51, 6144
  s_nop 0
  buffer_load_dwordx4 v112, s[4:7], s41 offen sc1 lds
  v_add_u32 v6, s50, v112
  v_add_u32 v113, 40960, v6
  v_add_u32 v5, s49, v112
  v_mfma_f32_16x16x32_bf16 v[72:75], v[116:119], v[16:19], 0
  v_mfma_f32_16x16x32_bf16 v[76:79], v[120:123], v[16:19], 0
  v_mfma_f32_16x16x32_bf16 v[80:83], v[124:127], v[16:19], 0
  v_mfma_f32_16x16x32_bf16 v[84:87], v[128:131], v[16:19], 0
  v_mfma_f32_16x16x32_bf16 v[88:91], v[132:135], v[16:19], 0
  v_mfma_f32_16x16x32_bf16 v[72:75], v[136:139], v[20:23], v[72:75]
  v_mfma_f32_16x16x32_bf16 v[76:79], v[140:143], v[20:23], v[76:79]
  v_mfma_f32_16x16x32_bf16 v[80:83], v[144:147], v[20:23], v[80:83]
  v_mfma_f32_16x16x32_bf16 v[84:87], v[148:151], v[20:23], v[84:87]
  v_mfma_f32_16x16x32_bf16 v[88:91], v[152:155], v[20:23], v[88:91]
  v_mfma_f32_16x16x32_bf16 v[72:75], v[156:159], v[24:27], v[72:75]
  v_mfma_f32_16x16x32_bf16 v[76:79], v[160:163], v[24:27], v[76:79]
  v_mfma_f32_16x16x32_bf16 v[80:83], v[164:167], v[24:27], v[80:83]
  v_mfma_f32_16x16x32_bf16 v[84:87], v[168:171], v[24:27], v[84:87]
  v_mfma_f32_16x16x32_bf16 v[88:91], v[172:175], v[24:27], v[88:91]
  v_mfma_f32_16x16x32_bf16 v[72:75], v[176:179], v[28:31], v[72:75]
  v_mfma_f32_16x16x32_bf16 v[76:79], v[180:183], v[28:31], v[76:79]
  v_mfma_f32_16x16x32_bf16 v[80:83], v[184:187], v[28:31], v[80:83]
  v_mfma_f32_16x16x32_bf16 v[84:87], v[188:191], v[28:31], v[84:87]
  v_mfma_f32_16x16x32_bf16 v[88:91], v[192:195], v[28:31], v[88:91]
  v_mfma_f32_16x16x32_bf16 v[72:75], v[196:199], v[32:35], v[72:75]
  v_mfma_f32_16x16x32_bf16 v[76:79], v[200:203], v[32:35], v[76:79]
  v_mfma_f32_16x16x32_bf16 v[80:83], v[204:207], v[32:35], v[80:83]
  v_mfma_f32_16x16x32_bf16 v[84:87], v[208:211], v[32:35], v[84:87]
  v_mfma_f32_16x16x32_bf16 v[88:91], v[212:215], v[32:35], v[88:91]
  v_mfma_f32_16x16x32_bf16 v[72:75], v[216:219], v[36:39], v[72:75]
  v_mfma_f32_16x16x32_bf16 v[76:79], v[220:223], v[36:39], v[76:79]
  v_mfma_f32_16x16x32_bf16 v[80:83], v[224:227], v[36:39], v[80:83]
  v_mfma_f32_16x16x32_bf16 v[84:87], v[228:231], v[36:39], v[84:87]
  v_mfma_f32_16x16x32_bf16 v[88:91], v[232:235], v[36:39], v[88:91]
  v_mfma_f32_16x16x32_bf16 v[72:75], v[236:239], v[40:43], v[72:75]
  v_mfma_f32_16x16x32_bf16 v[76:79], v[240:243], v[40:43], v[76:79]
  v_mfma_f32_16x16x32_bf16 v[80:83], v[244:247], v[40:43], v[80:83]
  v_mfma_f32_16x16x32_bf16 v[84:87], v[248:251], v[40:43], v[84:87]
  v_mfma_f32_16x16x32_bf16 v[88:91], v[252:255], v[40:43], v[88:91]
  s_waitcnt vmcnt(7)
  v_max3_u32 v4, v44, v45, v46
  v_max3_u32 v4, v4, v47, v48
  v_max3_u32 v4, v4, v49, v50
  v_max3_u32 v4, v4, v51, v52
  v_max3_u32 v4, v4, v53, v54
  v_max3_u32 v4, v4, v55, v56
  v_max3_u32 v4, v4, v57, v58
  v_max3_u32 v4, v4, v59, v60
  v_max3_u32 v4, v4, v61, v62
  v_max3_u32 v4, v4, v63, v64
  v_max3_u32 v4, v4, v65, v66
  v_max3_u32 v4, v4, v67, v68
  v_max3_u32 v4, v4, v69, v70
  v_max_u32 v4, v4, v71
  v_cmp_eq_u32 vcc, -1, v4
  s_cmp_eq_u64 vcc, 0
  s_cbranch_scc1 p5_ok_149
  s_mov_b32 s61, 0
pl_top_150:
  s_add_u32 s41, s44, 1024
  buffer_load_dwordx4 v[44:47], v112, s[4:7], s41 offen sc1
  s_add_u32 s41, s44, 5120
  buffer_load_dwordx4 v[48:51], v112, s[4:7], s41 offen sc1
  s_add_u32 s41, s44, 9216
  buffer_load_dwordx4 v[52:55], v112, s[4:7], s41 offen sc1
  s_add_u32 s41, s44, 13312
  buffer_load_dwordx4 v[56:59], v112, s[4:7], s41 offen sc1
  s_add_u32 s41, s44, 17408
  buffer_load_dwordx4 v[60:63], v112, s[4:7], s41 offen sc1
  s_add_u32 s41, s44, 21504
  buffer_load_dwordx4 v[64:67], v112, s[4:7], s41 offen sc1
  s_add_u32 s41, s44, s45
  s_add_u32 s41, s41, 1024
  buffer_load_dwordx4 v[68:71], v112, s[4:7], s41 offen sc1
pl_chk_151:
  s_waitcnt vmcnt(0)
  v_max3_u32 v4, v44, v45, v46
  v_max3_u32 v4, v4, v47, v48
  v_max3_u32 v4, v4, v49, v50
  v_max3_u32 v4, v4, v51, v52
  v_max3_u32 v4, v4, v53, v54
  v_max3_u32 v4, v4, v55, v56
  v_max3_u32 v4, v4, v57, v58
  v_max3_u32 v4, v4, v59, v60
  v_max3_u32 v4, v4, v61, v62
  v_max3_u32 v4, v4, v63, v64
  v_max3_u32 v4, v4, v65, v66
  v_max3_u32 v4, v4, v67, v68
  v_max3_u32 v4, v4, v69, v70
  v_max_u32 v4, v4, v71
  v_cmp_eq_u32 vcc, -1, v4
  s_cmp_eq_u64 vcc, 0
  s_cbranch_scc1 pl_ok_152
  s_add_u32 s61, s61, 1
  s_cmp_lt_u32 s61, 1048576
  s_sleep 1
  s_cbranch_scc1 pl_top_150
pl_ok_152:
p5_ok_149:
  v_mfma_f32_16x16x32_bf16 v[92:95], v[116:119], v[44:47], 0
  v_mfma_f32_16x16x32_bf16 v[96:99], v[120:123], v[44:47], 0
  v_mfma_f32_16x16x32_bf16 v[100:103], v[124:127], v[44:47], 0
  v_mfma_f32_16x16x32_bf16 v[104:107], v[128:131], v[44:47], 0
  v_mfma_f32_16x16x32_bf16 v[108:111], v[132:135], v[44:47], 0
  ds_write_b128 v5, v[72:75] offset:0
  ds_write_b128 v5, v[76:79] offset:1024
  ds_write_b128 v5, v[80:83] offset:2048
  ds_write_b128 v5, v[84:87] offset:3072
  ds_write_b128 v5, v[88:91] offset:4096
  v_mfma_f32_16x16x32_bf16 v[92:95], v[136:139], v[48:51], v[92:95]
  v_mfma_f32_16x16x32_bf16 v[96:99], v[140:143], v[48:51], v[96:99]
  v_mfma_f32_16x16x32_bf16 v[100:103], v[144:147], v[48:51], v[100:103]
  v_mfma_f32_16x16x32_bf16 v[104:107], v[148:151], v[48:51], v[104:107]
  v_mfma_f32_16x16x32_bf16 v[108:111], v[152:155], v[48:51], v[108:111]
  v_mfma_f32_16x16x32_bf16 v[92:95], v[156:159], v[52:55], v[92:95]
  v_mfma_f32_16x16x32_bf16 v[96:99], v[160:163], v[52:55], v[96:99]
  v_mfma_f32_16x16x32_bf16 v[100:103], v[164:167], v[52:55], v[100:103]
  v_mfma_f32_16x16x32_bf16 v[104:107], v[168:171], v[52:55], v[104:107]
  v_mfma_f32_16x16x32_bf16 v[108:111], v[172:175], v[52:55], v[108:111]
  v_mfma_f32_16x16x32_bf16 v[92:95], v[176:179], v[56:59], v[92:95]
  v_mfma_f32_16x16x32_bf16 v[96:99], v[180:183], v[56:59], v[96:99]
  v_mfma_f32_16x16x32_bf16 v[100:103], v[184:187], v[56:59], v[100:103]
  v_mfma_f32_16x16x32_bf16 v[104:107], v[188:191], v[56:59], v[104:107]
  v_mfma_f32_16x16x32_bf16 v[108:111], v[192:195], v[56:59], v[108:111]
  s_waitcnt lgkmcnt(0)
  s_barrier
  ds_read_b128 v[72:75], v6 offset:0
  ds_read_b128 v[76:79], v6 offset:5120
  ds_read_b128 v[80:83], v6 offset:10240
  ds_read_b128 v[84:87], v6 offset:15360
  v_mfma_f32_16x16x32_bf16 v[92:95], v[196:199], v[60:63], v[92:95]
  v_mfma_f32_16x16x32_bf16 v[96:99], v[200:203], v[60:63], v[96:99]
  v_mfma_f32_16x16x32_bf16 v[100:103], v[204:207], v[60:63], v[100:103]
  v_mfma_f32_16x16x32_bf16 v[104:107], v[208:211], v[60:63], v[104:107]
  v_mfma_f32_16x16x32_bf16 v[108:111], v[212:215], v[60:63], v[108:111]
  s_waitcnt lgkmcnt(0)
  v_add_f32 v72, v72, v76
  v_add_f32 v80, v80, v84
  v_add_f32 v73, v73, v77
  v_add_f32 v81, v81, v85
  v_add_f32 v74, v74, v78
  v_add_f32 v82, v82, v86
  v_add_f32 v75, v75, v79
  v_add_f32 v83, v83, v87
  v_add_f32 v88, v72, v80
  v_add_f32 v89, v73, v81
  v_add_f32 v90, v74, v82
  v_add_f32 v91, v75, v83
  ds_read_b128 v[72:75], v6 offset:20480
  ds_read_b128 v[76:79], v6 offset:25600
  ds_read_b128 v[80:83], v6 offset:30720
  ds_read_b128 v[84:87], v6 offset:35840
  v_mfma_f32_16x16x32_bf16 v[92:95], v[216:219], v[64:67], v[92:95]
  v_mfma_f32_16x16x32_bf16 v[96:99], v[220:223], v[64:67], v[96:99]
  v_mfma_f32_16x16x32_bf16 v[100:103], v[224:227], v[64:67], v[100:103]
  v_mfma_f32_16x16x32_bf16 v[104:107], v[228:231], v[64:67], v[104:107]
  v_mfma_f32_16x16x32_bf16 v[108:111], v[232:235], v[64:67], v[108:111]
  v_mfma_f32_16x16x32_bf16 v[92:95], v[236:239], v[68:71], v[92:95]
  v_mfma_f32_16x16x32_bf16 v[96:99], v[240:243], v[68:71], v[96:99]
  v_mfma_f32_16x16x32_bf16 v[100:103], v[244:247], v[68:71], v[100:103]
  v_mfma_f32_16x16x32_bf16 v[104:107], v[248:251], v[68:71], v[104:107]
  v_mfma_f32_16x16x32_bf16 v[108:111], v[252:255], v[68:71], v[108:111]
  s_waitcnt lgkmcnt(0)
  v_add_f32 v72, v72, v76
  v_add_f32 v80, v80, v84
  v_add_f32 v73, v73, v77
  v_add_f32 v81, v81, v85
  v_add_f32 v74, v74, v78
  v_add_f32 v82, v82, v86
  v_add_f32 v75, v75, v79
  v_add_f32 v83, v83, v87
  v_add_f32 v72, v72, v80
  v_add_f32 v72, v72, v88
  v_add_f32 v73, v73, v81
  v_add_f32 v73, v73, v89
  v_add_f32 v74, v74, v82
  v_add_f32 v74, v74, v90
  v_add_f32 v75, v75, v83
  v_add_f32 v75, v75, v91
  s_waitcnt vmcnt(0)
  v_lshlrev_b32 v80, 16, v10
  v_and_b32 v81, 0xffff0000, v10
  v_lshlrev_b32 v82, 16, v11
  v_and_b32 v83, 0xffff0000, v11
  v_add_f32 v80, v80, v72
  v_add_f32 v81, v81, v73
  v_add_f32 v82, v82, v74
  v_add_f32 v83, v83, v75
  v_cvt_pk_bf16_f32 v84, v80, v81
  v_cvt_pk_bf16_f32 v85, v82, v83
  s_cmp_ge_u32 s32, 5
  s_cbranch_scc1 P5_nost_153
  s_add_u32 s41, s48, 0
  buffer_store_dwordx2 v[84:85], v7, s[28:31], s41 offen
P5_nost_153:
  s_add_u32 s41, s44, 3072
  buffer_load_dwordx4 v[44:47], v112, s[4:7], s41 offen sc1
  s_add_u32 s41, s44, 7168
  buffer_load_dwordx4 v[48:51], v112, s[4:7], s41 offen sc1
  s_add_u32 s41, s44, 11264
  buffer_load_dwordx4 v[52:55], v112, s[4:7], s41 offen sc1
  s_add_u32 s41, s44, 15360
  buffer_load_dwordx4 v[56:59], v112, s[4:7], s41 offen sc1
  s_add_u32 s41, s44, 19456
  buffer_load_dwordx4 v[60:63], v112, s[4:7], s41 offen sc1
  s_add_u32 s41, s44, 23552
  buffer_load_dwordx4 v[64:67], v112, s[4:7], s41 offen sc1
  s_add_u32 s41, s44, s45
  s_add_u32 s41, s41, 3072
  buffer_load_dwordx4 v[68:71], v112, s[4:7], s41 offen sc1
  ds_read_b128 v[16:19], v8 offset:0
  ds_read_b128 v[20:23], v8 offset:1024
  ds_read_b128 v[24:27], v8 offset:2048
  ds_read_b128 v[28:31], v8 offset:3072
  ds_read_b128 v[32:35], v8 offset:4096
  ds_read_b128 v[36:39], v8 offset:5120
  ds_read_b128 v[40:43], v8 offset:6144
  s_waitcnt lgkmcnt(0)
  v_max3_u32 v4, v16, v17, v18
  v_max3_u32 v4, v4, v19, v20
  v_max3_u32 v4, v4, v21, v22
  v_max3_u32 v4, v4, v23, v24
  v_max3_u32 v4, v4, v25, v26
  v_max3_u32 v4, v4, v27, v28
  v_max3_u32 v4, v4, v29, v30
  v_max3_u32 v4, v4, v31, v32
  v_max3_u32 v4, v4, v33, v34
  v_max3_u32 v4, v4, v35, v36
  v_max3_u32 v4, v4, v37, v38
  v_max3_u32 v4, v4, v39, v40
  v_max3_u32 v4, v4, v41, v42
  v_max_u32 v4, v4, v43
  v_cmp_eq_u32 vcc, -1, v4
  s_cmp_eq_u64 vcc, 0
  s_cbranch_scc1 p5_ok_154
  s_mov_b32 s61, 0
pl_top_155:
  s_add_u32 s41, s44, 2048
  buffer_load_dwordx4 v[16:19], v112, s[4:7], s41 offen sc1
  s_add_u32 s41, s44, 6144
  buffer_load_dwordx4 v[20:23], v112, s[4:7], s41 offen sc1
  s_add_u32 s41, s44, 10240
  buffer_load_dwordx4 v[24:27], v112, s[4:7], s41 offen sc1
  s_add_u32 s41, s44, 14336
  buffer_load_dwordx4 v[28:31], v112, s[4:7], s41 offen sc1
  s_add_u32 s41, s44, 18432
  buffer_load_dwordx4 v[32:35], v112, s[4:7], s41 offen sc1
  s_add_u32 s41, s44, 22528
  buffer_load_dwordx4 v[36:39], v112, s[4:7], s41 offen sc1
  s_add_u32 s41, s44, s45
  s_add_u32 s41, s41, 2048
  buffer_load_dwordx4 v[40:43], v112, s[4:7], s41 offen sc1
pl_chk_156:
  s_waitcnt vmcnt(0)
  v_max3_u32 v4, v16, v17, v18
  v_max3_u32 v4, v4, v19, v20
  v_max3_u32 v4, v4, v21, v22
  v_max3_u32 v4, v4, v23, v24
  v_max3_u32 v4, v4, v25, v26
  v_max3_u32 v4, v4, v27, v28
  v_max3_u32 v4, v4, v29, v30
  v_max3_u32 v4, v4, v31, v32
  v_max3_u32 v4, v4, v33, v34
  v_max3_u32 v4, v4, v35, v36
  v_max3_u32 v4, v4, v37, v38
  v_max3_u32 v4, v4, v39, v40
  v_max3_u32 v4, v4, v41, v42
  v_max_u32 v4, v4, v43
  v_cmp_eq_u32 vcc, -1, v4
  s_cmp_eq_u64 vcc, 0
  s_cbranch_scc1 pl_ok_157
  s_add_u32 s61, s61, 1
  s_cmp_lt_u32 s61, 1048576
  s_sleep 1
  s_cbranch_scc1 pl_top_155
pl_ok_157:
p5_ok_154:
  v_mfma_f32_16x16x32_bf16 v[72:75], v[116:119], v[16:19], 0
  v_mfma_f32_16x16x32_bf16 v[76:79], v[120:123], v[16:19], 0
  v_mfma_f32_16x16x32_bf16 v[80:83], v[124:127], v[16:19], 0
  v_mfma_f32_16x16x32_bf16 v[84:87], v[128:131], v[16:19], 0
  v_mfma_f32_16x16x32_bf16 v[88:91], v[132:135], v[16:19], 0
  ds_write_b128 v5, v[92:95] offset:40960
  ds_write_b128 v5, v[96:99] offset:41984
  ds_write_b128 v5, v[100:103] offset:43008
  ds_write_b128 v5, v[104:107] offset:44032
  ds_write_b128 v5, v[108:111] offset:45056
  v_mfma_f32_16x16x32_bf16 v[72:75], v[136:139], v[20:23], v[72:75]
  v_mfma_f32_16x16x32_bf16 v[76:79], v[140:143], v[20:23], v[76:79]
  v_mfma_f32_16x16x32_bf16 v[80:83], v[144:147], v[20:23], v[80:83]
  v_mfma_f32_16x16x32_bf16 v[84:87], v[148:151], v[20:23], v[84:87]
  v_mfma_f32_16x16x32_bf16 v[88:91], v[152:155], v[20:23], v[88:91]
  v_mfma_f32_16x16x32_bf16 v[72:75], v[156:159], v[24:27], v[72:75]
  v_mfma_f32_16x16x32_bf16 v[76:79], v[160:163], v[24:27], v[76:79]
  v_mfma_f32_16x16x32_bf16 v[80:83], v[164:167], v[24:27], v[80:83]
  v_mfma_f32_16x16x32_bf16 v[84:87], v[168:171], v[24:27], v[84:87]
  v_mfma_f32_16x16x32_bf16 v[88:91], v[172:175], v[24:27], v[88:91]
  v_mfma_f32_16x16x32_bf16 v[72:75], v[176:179], v[28:31], v[72:75]
  v_mfma_f32_16x16x32_bf16 v[76:79], v[180:183], v[28:31], v[76:79]
  v_mfma_f32_16x16x32_bf16 v[80:83], v[184:187], v[28:31], v[80:83]
  v_mfma_f32_16x16x32_bf16 v[84:87], v[188:191], v[28:31], v[84:87]
  v_mfma_f32_16x16x32_bf16 v[88:91], v[192:195], v[28:31], v[88:91]
  s_waitcnt lgkmcnt(0)
  s_barrier
  ds_read_b128 v[92:95], v113 offset:0
  ds_read_b128 v[96:99], v113 offset:5120
  ds_read_b128 v[100:103], v113 offset:10240
  ds_read_b128 v[104:107], v113 offset:15360
  v_mfma_f32_16x16x32_bf16 v[72:75], v[196:199], v[32:35], v[72:75]
  v_mfma_f32_16x16x32_bf16 v[76:79], v[200:203], v[32:35], v[76:79]
  v_mfma_f32_16x16x32_bf16 v[80:83], v[204:207], v[32:35], v[80:83]
  v_mfma_f32_16x16x32_bf16 v[84:87], v[208:211], v[32:35], v[84:87]
  v_mfma_f32_16x16x32_bf16 v[88:91], v[212:215], v[32:35], v[88:91]
  s_waitcnt lgkmcnt(0)
  v_add_f32 v92, v92, v96
  v_add_f32 v100, v100, v104
  v_add_f32 v93, v93, v97
  v_add_f32 v101, v101, v105
  v_add_f32 v94, v94, v98
  v_add_f32 v102, v102, v106
  v_add_f32 v95, v95, v99
  v_add_f32 v103, v103, v107
  v_add_f32 v108, v92, v100
  v_add_f32 v109, v93, v101
  v_add_f32 v110, v94, v102
  v_add_f32 v111, v95, v103
  ds_read_b128 v[92:95], v113 offset:20480
  ds_read_b128 v[96:99], v113 offset:25600
  ds_read_b128 v[100:103], v113 offset:30720
  ds_read_b128 v[104:107], v113 offset:35840
  v_mfma_f32_16x16x32_bf16 v[72:75], v[216:219], v[36:39], v[72:75]
  v_mfma_f32_16x16x32_bf16 v[76:79], v[220:223], v[36:39], v[76:79]
  v_mfma_f32_16x16x32_bf16 v[80:83], v[224:227], v[36:39], v[80:83]
  v_mfma_f32_16x16x32_bf16 v[84:87], v[228:231], v[36:39], v[84:87]
  v_mfma_f32_16x16x32_bf16 v[88:91], v[232:235], v[36:39], v[88:91]
  v_mfma_f32_16x16x32_bf16 v[72:75], v[236:239], v[40:43], v[72:75]
  v_mfma_f32_16x16x32_bf16 v[76:79], v[240:243], v[40:43], v[76:79]
  v_mfma_f32_16x16x32_bf16 v[80:83], v[244:247], v[40:43], v[80:83]
  v_mfma_f32_16x16x32_bf16 v[84:87], v[248:251], v[40:43], v[84:87]
  v_mfma_f32_16x16x32_bf16 v[88:91], v[252:255], v[40:43], v[88:91]
  s_waitcnt lgkmcnt(0)
  v_add_f32 v92, v92, v96
  v_add_f32 v100, v100, v104
  v_add_f32 v93, v93, v97
  v_add_f32 v101, v101, v105
  v_add_f32 v94, v94, v98
  v_add_f32 v102, v102, v106
  v_add_f32 v95, v95, v99
  v_add_f32 v103, v103, v107
  v_add_f32 v92, v92, v100
  v_add_f32 v92, v92, v108
  v_add_f32 v93, v93, v101
  v_add_f32 v93, v93, v109
  v_add_f32 v94, v94, v102
  v_add_f32 v94, v94, v110
  v_add_f32 v95, v95, v103
  v_add_f32 v95, v95, v111
  s_waitcnt vmcnt(0)
  v_lshlrev_b32 v100, 16, v12
  v_and_b32 v101, 0xffff0000, v12
  v_lshlrev_b32 v102, 16, v13
  v_and_b32 v103, 0xffff0000, v13
  v_add_f32 v100, v100, v92
  v_add_f32 v101, v101, v93
  v_add_f32 v102, v102, v94
  v_add_f32 v103, v103, v95
  v_cvt_pk_bf16_f32 v104, v100, v101
  v_cvt_pk_bf16_f32 v105, v102, v103
  s_cmp_ge_u32 s32, 5
  s_cbranch_scc1 P5_nost_158
  s_add_u32 s41, s48, 20480
  buffer_store_dwordx2 v[104:105], v7, s[28:31], s41 offen
P5_nost_158:
  s_nop 0
  v_max3_u32 v4, v44, v45, v46
  v_max3_u32 v4, v4, v47, v48
  v_max3_u32 v4, v4, v49, v50
  v_max3_u32 v4, v4, v51, v52
  v_max3_u32 v4, v4, v53, v54
  v_max3_u32 v4, v4, v55, v56
  v_max3_u32 v4, v4, v57, v58
  v_max3_u32 v4, v4, v59, v60
  v_max3_u32 v4, v4, v61, v62
  v_max3_u32 v4, v4, v63, v64
  v_max3_u32 v4, v4, v65, v66
  v_max3_u32 v4, v4, v67, v68
  v_max3_u32 v4, v4, v69, v70
  v_max_u32 v4, v4, v71
  v_cmp_eq_u32 vcc, -1, v4
  s_cmp_eq_u64 vcc, 0
  s_cbranch_scc1 p5_ok_159
  s_mov_b32 s61, 0
pl_top_160:
  s_add_u32 s41, s44, 3072
  buffer_load_dwordx4 v[44:47], v112, s[4:7], s41 offen sc1
  s_add_u32 s41, s44, 7168
  buffer_load_dwordx4 v[48:51], v112, s[4:7], s41 offen sc1
  s_add_u32 s41, s44, 11264
  buffer_load_dwordx4 v[52:55], v112, s[4:7], s41 offen sc1
  s_add_u32 s41, s44, 15360
  buffer_load_dwordx4 v[56:59], v112, s[4:7], s41 offen sc1
  s_add_u32 s41, s44, 19456
  buffer_load_dwordx4 v[60:63], v112, s[4:7], s41 offen sc1
  s_add_u32 s41, s44, 23552
  buffer_load_dwordx4 v[64:67], v112, s[4:7], s41 offen sc1
  s_add_u32 s41, s44, s45
  s_add_u32 s41, s41, 3072
  buffer_load_dwordx4 v[68:71], v112, s[4:7], s41 offen sc1
pl_chk_161:
  s_waitcnt vmcnt(0)
  v_max3_u32 v4, v44, v45, v46
  v_max3_u32 v4, v4, v47, v48
  v_max3_u32 v4, v4, v49, v50
  v_max3_u32 v4, v4, v51, v52
  v_max3_u32 v4, v4, v53, v54
  v_max3_u32 v4, v4, v55, v56
  v_max3_u32 v4, v4, v57, v58
  v_max3_u32 v4, v4, v59, v60
  v_max3_u32 v4, v4, v61, v62
  v_max3_u32 v4, v4, v63, v64
  v_max3_u32 v4, v4, v65, v66
  v_max3_u32 v4, v4, v67, v68
  v_max3_u32 v4, v4, v69, v70
  v_max_u32 v4, v4, v71
  v_cmp_eq_u32 vcc, -1, v4
  s_cmp_eq_u64 vcc, 0
  s_cbranch_scc1 pl_ok_162
  s_add_u32 s61, s61, 1
  s_cmp_lt_u32 s61, 1048576
  s_sleep 1
  s_cbranch_scc1 pl_top_160
pl_ok_162:
p5_ok_159:
  v_mfma_f32_16x16x32_bf16 v[92:95], v[116:119], v[44:47], 0
  v_mfma_f32_16x16x32_bf16 v[96:99], v[120:123], v[44:47], 0
  v_mfma_f32_16x16x32_bf16 v[100:103], v[124:127], v[44:47], 0
  v_mfma_f32_16x16x32_bf16 v[104:107], v[128:131], v[44:47], 0
  v_mfma_f32_16x16x32_bf16 v[108:111], v[132:135], v[44:47], 0
  ds_write_b128 v5, v[72:75] offset:0
  ds_write_b128 v5, v[76:79] offset:1024
  ds_write_b128 v5, v[80:83] offset:2048
  ds_write_b128 v5, v[84:87] offset:3072
  ds_write_b128 v5, v[88:91] offset:4096
  v_mfma_f32_16x16x32_bf16 v[92:95], v[136:139], v[48:51], v[92:95]
  v_mfma_f32_16x16x32_bf16 v[96:99], v[140:143], v[48:51], v[96:99]
  v_mfma_f32_16x16x32_bf16 v[100:103], v[144:147], v[48:51], v[100:103]
  v_mfma_f32_16x16x32_bf16 v[104:107], v[148:151], v[48:51], v[104:107]
  v_mfma_f32_16x16x32_bf16 v[108:111], v[152:155], v[48:51], v[108:111]
  v_mfma_f32_16x16x32_bf16 v[92:95], v[156:159], v[52:55], v[92:95]
  v_mfma_f32_16x16x32_bf16 v[96:99], v[160:163], v[52:55], v[96:99]
  v_mfma_f32_16x16x32_bf16 v[100:103], v[164:167], v[52:55], v[100:103]
  v_mfma_f32_16x16x32_bf16 v[104:107], v[168:171], v[52:55], v[104:107]
  v_mfma_f32_16x16x32_bf16 v[108:111], v[172:175], v[52:55], v[108:111]
  v_mfma_f32_16x16x32_bf16 v[92:95], v[176:179], v[56:59], v[92:95]
  v_mfma_f32_16x16x32_bf16 v[96:99], v[180:183], v[56:59], v[96:99]
  v_mfma_f32_16x16x32_bf16 v[100:103], v[184:187], v[56:59], v[100:103]
  v_mfma_f32_16x16x32_bf16 v[104:107], v[188:191], v[56:59], v[104:107]
  v_mfma_f32_16x16x32_bf16 v[108:111], v[192:195], v[56:59], v[108:111]
  s_waitcnt lgkmcnt(0)
  s_barrier
  ds_read_b128 v[72:75], v6 offset:0
  ds_read_b128 v[76:79], v6 offset:5120
  ds_read_b128 v[80:83], v6 offset:10240
  ds_read_b128 v[84:87], v6 offset:15360
  v_mfma_f32_16x16x32_bf16 v[92:95], v[196:199], v[60:63], v[92:95]
  v_mfma_f32_16x16x32_bf16 v[96:99], v[200:203], v[60:63], v[96:99]
  v_mfma_f32_16x16x32_bf16 v[100:103], v[204:207], v[60:63], v[100:103]
  v_mfma_f32_16x16x32_bf16 v[104:107], v[208:211], v[60:63], v[104:107]
  v_mfma_f32_16x16x32_bf16 v[108:111], v[212:215], v[60:63], v[108:111]
  s_waitcnt lgkmcnt(0)
  v_add_f32 v72, v72, v76
  v_add_f32 v80, v80, v84
  v_add_f32 v73, v73, v77
  v_add_f32 v81, v81, v85
  v_add_f32 v74, v74, v78
  v_add_f32 v82, v82, v86
  v_add_f32 v75, v75, v79
  v_add_f32 v83, v83, v87
  v_add_f32 v88, v72, v80
  v_add_f32 v89, v73, v81
  v_add_f32 v90, v74, v82
  v_add_f32 v91, v75, v83
  ds_read_b128 v[72:75], v6 offset:20480
  ds_read_b128 v[76:79], v6 offset:25600
  ds_read_b128 v[80:83], v6 offset:30720
  ds_read_b128 v[84:87], v6 offset:35840
  v_mfma_f32_16x16x32_bf16 v[92:95], v[216:219], v[64:67], v[92:95]
  v_mfma_f32_16x16x32_bf16 v[96:99], v[220:223], v[64:67], v[96:99]
  v_mfma_f32_16x16x32_bf16 v[100:103], v[224:227], v[64:67], v[100:103]
  v_mfma_f32_16x16x32_bf16 v[104:107], v[228:231], v[64:67], v[104:107]
  v_mfma_f32_16x16x32_bf16 v[108:111], v[232:235], v[64:67], v[108:111]
  v_mfma_f32_16x16x32_bf16 v[92:95], v[236:239], v[68:71], v[92:95]
  v_mfma_f32_16x16x32_bf16 v[96:99], v[240:243], v[68:71], v[96:99]
  v_mfma_f32_16x16x32_bf16 v[100:103], v[244:247], v[68:71], v[100:103]
  v_mfma_f32_16x16x32_bf16 v[104:107], v[248:251], v[68:71], v[104:107]
  v_mfma_f32_16x16x32_bf16 v[108:111], v[252:255], v[68:71], v[108:111]
  s_waitcnt lgkmcnt(0)
  v_add_f32 v72, v72, v76
  v_add_f32 v80, v80, v84
  v_add_f32 v73, v73, v77
  v_add_f32 v81, v81, v85
  v_add_f32 v74, v74, v78
  v_add_f32 v82, v82, v86
  v_add_f32 v75, v75, v79
  v_add_f32 v83, v83, v87
  v_add_f32 v72, v72, v80
  v_add_f32 v72, v72, v88
  v_add_f32 v73, v73, v81
  v_add_f32 v73, v73, v89
  v_add_f32 v74, v74, v82
  v_add_f32 v74, v74, v90
  v_add_f32 v75, v75, v83
  v_add_f32 v75, v75, v91
  v_lshlrev_b32 v80, 16, v14
  v_and_b32 v81, 0xffff0000, v14
  v_lshlrev_b32 v82, 16, v15
  v_and_b32 v83, 0xffff0000, v15
  v_add_f32 v80, v80, v72
  v_add_f32 v81, v81, v73
  v_add_f32 v82, v82, v74
  v_add_f32 v83, v83, v75
  v_cvt_pk_bf16_f32 v84, v80, v81
  v_cvt_pk_bf16_f32 v85, v82, v83
  s_cmp_ge_u32 s32, 5
  s_cbranch_scc1 P5_nost_163
  s_add_u32 s41, s48, 40960
  buffer_store_dwordx2 v[84:85], v7, s[28:31], s41 offen
P5_nost_163:
  ds_write_b128 v5, v[92:95] offset:40960
  ds_write_b128 v5, v[96:99] offset:41984
  ds_write_b128 v5, v[100:103] offset:43008
  ds_write_b128 v5, v[104:107] offset:44032
  ds_write_b128 v5, v[108:111] offset:45056
  s_waitcnt lgkmcnt(0)
  s_barrier
  ds_read_b128 v[16:19], v113 offset:0
  ds_read_b128 v[20:23], v113 offset:5120
  ds_read_b128 v[24:27], v113 offset:10240
  ds_read_b128 v[28:31], v113 offset:15360
  ds_read_b128 v[32:35], v113 offset:20480
  ds_read_b128 v[36:39], v113 offset:25600
  ds_read_b128 v[40:43], v113 offset:30720
  ds_read_b128 v[44:47], v113 offset:35840
  s_waitcnt lgkmcnt(0)
  v_add_f32 v16, v16, v20
  v_add_f32 v24, v24, v28
  v_add_f32 v32, v32, v36
  v_add_f32 v40, v40, v44
  v_add_f32 v17, v17, v21
  v_add_f32 v25, v25, v29
  v_add_f32 v33, v33, v37
  v_add_f32 v41, v41, v45
  v_add_f32 v18, v18, v22
  v_add_f32 v26, v26, v30
  v_add_f32 v34, v34, v38
  v_add_f32 v42, v42, v46
  v_add_f32 v19, v19, v23
  v_add_f32 v27, v27, v31
  v_add_f32 v35, v35, v39
  v_add_f32 v43, v43, v47
  v_add_f32 v16, v16, v24
  v_add_f32 v32, v32, v40
  v_add_f32 v17, v17, v25
  v_add_f32 v33, v33, v41
  v_add_f32 v18, v18, v26
  v_add_f32 v34, v34, v42
  v_add_f32 v19, v19, v27
  v_add_f32 v35, v35, v43
  v_add_f32 v92, v16, v32
  v_add_f32 v93, v17, v33
  v_add_f32 v94, v18, v34
  v_add_f32 v95, v19, v35
  v_lshlrev_b32 v100, 16, v114
  v_and_b32 v101, 0xffff0000, v114
  v_lshlrev_b32 v102, 16, v115
  v_and_b32 v103, 0xffff0000, v115
  v_add_f32 v100, v100, v92
  v_add_f32 v101, v101, v93
  v_add_f32 v102, v102, v94
  v_add_f32 v103, v103, v95
  v_cvt_pk_bf16_f32 v104, v100, v101
  v_cvt_pk_bf16_f32 v105, v102, v103
  s_cmp_ge_u32 s32, 5
  s_cbranch_scc1 P5_nost_164
  s_add_u32 s41, s48, 61440
  buffer_store_dwordx2 v[104:105], v7, s[28:31], s41 offen
P5_nost_164:
  s_or_b32 s60, s2, s32
  s_cmp_eq_u32 s60, 0
  s_cbranch_scc0 epoch_165
  v_mov_b32 v2, s35
  v_mov_b32 v3, 0
  s_mov_b64 exec, 1
  buffer_store_dword v2, v3, s[4:7], 0 offen offset:0
  s_mov_b64 exec, -1
epoch_165:
L_end:
  s_endpgm
L_code_end:
  s_endpgm
.section .rodata,"a"
.p2align 6
.amdhsa_kernel sequential_preLN__softmax_full_mha__dense_activation_relu__prompt_kernel
  .amdhsa_next_free_vgpr 256
  .amdhsa_next_free_sgpr 102
  .amdhsa_accum_offset 256
  .amdhsa_group_segment_fixed_size 0
  .amdhsa_kernarg_size 72
  .amdhsa_user_sgpr_count 2
  .amdhsa_user_sgpr_kernarg_segment_ptr 1
  .amdhsa_system_sgpr_workgroup_id_x 1
.end_amdhsa_kernel
```
